```python
import torch

def _softmax(x, axis=-1):
    return torch.softmax(x, dim=axis)
def _gelu(x):
    return torch.nn.functional.gelu(x, approximate="tanh")
def _silu(x):
    return torch.nn.functional.silu(x)
def _sigmoid(x):
    return torch.sigmoid(x)
def _layernorm(x, axis=-1, eps=1e-5):
    m = x.mean(dim=axis, keepdim=True)
    v = x.var(dim=axis, keepdim=True, unbiased=False)
    return (x - m) / torch.sqrt(v + eps)
def _scatter_add(tgt, idx, src, axis=0):
    return tgt.clone().index_add_(axis, idx, src)
def _segment_sum(src, seg, n):
    out = torch.zeros((n,) + src.shape[1:], dtype=src.dtype)
    return out.index_add_(0, seg, src)
def _pad(x, pw):
    flat = tuple(v for pair in reversed(pw) for v in pair)
    return torch.nn.functional.pad(x, flat)

kernel_name = 'parallel_sum__softmax_full_mha__glu_gated_reglu__prompt'

def setup_inputs():

    _w = (lambda a: (lambda t: t.to(torch.bfloat16) if t.is_floating_point() else t)(torch.as_tensor(a)))
    def _A_setup():
        B, S, D = 1, 2048, 512
        return {
            "x": _w((lambda *s: torch.randn(*s, dtype=torch.bfloat16) * 0.05)(B, S, D)),
            "wqkv": _w((lambda *s: torch.randn(*s, dtype=torch.bfloat16) * 0.05)(D, 3 * D)),
            "wo": _w((lambda *s: torch.randn(*s, dtype=torch.bfloat16) * 0.05)(D, D)),
        }
    _A_in = _A_setup()

    def _B_setup():
        B, S, D, F = 1, 2048, 512, 1376
        return {
            "x": _w((lambda *s: torch.randn(*s, dtype=torch.bfloat16) * 0.05)(B, S, D)),
            "W_gate": _w((lambda *s: torch.randn(*s, dtype=torch.bfloat16) * 0.4)(D, F) * (2.0 / D) ** 0.5),
            "W_up": _w((lambda *s: torch.randn(*s, dtype=torch.bfloat16) * 0.4)(D, F) * (2.0 / D) ** 0.5),
            "W_down": _w((lambda *s: torch.randn(*s, dtype=torch.bfloat16) * 0.4)(F, D) * (1.0 / F) ** 0.5),
        }
    _B_in = _B_setup()

    return {
        "A_x": _A_in["x"],
        "A_wqkv": _A_in["wqkv"],
        "A_wo": _A_in["wo"],
        "B_x": _B_in["x"],
        "B_W_gate": _B_in["W_gate"],
        "B_W_up": _B_in["W_up"],
        "B_W_down": _B_in["W_down"],
    }

def reference(A_x, A_wqkv, A_wo, B_x, B_W_gate, B_W_up, B_W_down):
    def _A_ref(x, wqkv, wo):
        B, S, D = x.shape
        H = 32; Dh = D // H
        qkv = (lambda x, *d: x.permute(*d))((x @ wqkv).reshape(B, S, 3, H, Dh), 2, 0, 3, 1, 4)
        q, k, v = qkv[0], qkv[1], qkv[2]
        scale = Dh ** -0.5
        scores = torch.einsum("bhqd,bhkd->bhqk", q, k) * scale
        p = _softmax(scores, axis=-1)
        o = torch.einsum("bhqk,bhkd->bhqd", p, v)
        return (lambda x, *d: x.permute(*d))(o, 0, 2, 1, 3).reshape(B, S, D) @ wo

    def _B_ref(x, W_gate, W_up, W_down):
        gate = torch.einsum("bsd,df->bsf", x, W_gate)
        up = torch.einsum("bsd,df->bsf", x, W_up)
        gate = gate * (lambda x, dt: x.to(dt))(gate > 0, gate.dtype)
        h = gate * up
        return torch.einsum("bsf,fd->bsd", h, W_down)

    x = A_x
    xn = _layernorm(x, axis=-1)
    return x + _A_ref(xn, A_wqkv, A_wo) + _B_ref(xn, B_W_gate, B_W_up, B_W_down)
```

```asm
; @launch grid=(256,1,1) block=(512,1,1) lds=163840
.amdgcn_target "amdgcn-amd-amdhsa--gfx950"
.text
.globl parallel_sum__softmax_full_mha__glu_gated_reglu__prompt_kernel
.p2align 8
.type parallel_sum__softmax_full_mha__glu_gated_reglu__prompt_kernel,@function
parallel_sum__softmax_full_mha__glu_gated_reglu__prompt_kernel:
  s_cmp_ge_u32 s2, 0x100
  s_cbranch_scc1 L_end
  s_load_dwordx2 s[24:25], s[0:1], 0
  v_lshlrev_b32 v248, 7, v0
  v_subrev_u32 v248, 0x8000, v248
  v_cmp_le_i32 vcc, 0, v248
  s_cbranch_vccz L_nowarm
  s_getpc_b64 s[90:91]
L_pc:
  v_min_u32 v250, L_codeend-L_pc-4, v248
  v_mov_b32 v249, s91
  v_add_co_u32 v250, vcc, s90, v250
  v_addc_co_u32 v251, vcc, 0, v249, vcc
  global_load_dword v252, v[250:251], off
L_nowarm:
  s_load_dwordx2 s[28:29], s[0:1], 8
  s_load_dwordx2 s[52:53], s[0:1], 72
  s_load_dwordx2 s[32:33], s[0:1], 32
  s_load_dwordx2 s[36:37], s[0:1], 40
  s_load_dwordx2 s[40:41], s[0:1], 16
  s_load_dwordx2 s[4:5], s[0:1], 48
  s_load_dwordx2 s[44:45], s[0:1], 56
  s_load_dwordx2 s[48:49], s[0:1], 64
  v_lshrrev_b32 v1, 6, v0
  v_and_b32 v0, 63, v0
  s_and_b32 s57, s2, 7
  v_readfirstlane_b32 s56, v1
  s_lshr_b32 s58, s2, 3
  v_lshlrev_b32 v1, 4, v0
  s_and_b32 s62, s57, 3
  s_and_b32 s9, s58, 3
  s_lshl2_add_u32 s59, s62, s9
  s_lshr_b32 s62, s57, 2
  s_lshr_b32 s7, s58, 2
  s_lshl3_add_u32 s60, s62, s7
  s_lshl1_add_u32 s61, s9, s7
  s_and_b32 s61, s61, 7
  s_lshl2_add_u32 s6, s57, s9
  s_lshl3_add_u32 s8, s57, s7
  s_mov_b32 s26, 2097152
  s_mov_b32 s27, 0x00020000
  s_mov_b32 s30, 1572864
  s_mov_b32 s31, 0x00020000
  s_mov_b32 s34, 1409024
  s_mov_b32 s35, 0x00020000
  s_mov_b32 s38, 1409024
  s_mov_b32 s39, 0x00020000
  s_mov_b32 s42, 524288
  s_mov_b32 s43, 0x00020000
  s_mov_b32 s46, 2097152
  s_mov_b32 s47, 0x00020000
  s_mov_b32 s50, 256
  s_mov_b32 s51, 0x00020000
  s_mov_b32 s54, 16777216
  s_mov_b32 s55, 0x00020000
  s_cmp_ge_u32 s56, 4
  s_cbranch_scc1 L_helper
  s_setprio 3
  s_lshl2_add_u32 s63, s59, s56
  s_lshl_b32 s62, s63, 15
  v_lshrrev_b32 v2, 3, v0
  v_lshlrev_b32 v2, 10, v2
  v_add_u32 v2, s62, v2
  v_lshrrev_b32 v3, 4, v0
  v_and_b32 v4, 7, v0
  v_xor_b32 v5, v4, v3
  v_xor_b32 v6, 4, v5
  v_lshl_add_u32 v32, v5, 4, v2
  v_lshl_add_u32 v33, v6, 4, v2
  v_add_u32 v33, 7168, v33
  v_add_u32 v34, 14336, v32
  v_add_u32 v35, 14336, v33
  s_lshl_b32 s64, s56, 12
  s_add_u32 s64, s64, 32768
  s_lshl_b32 s65, s61, 7
  s_mov_b32 m0, s64
  s_waitcnt lgkmcnt(0)
  s_mov_b32 s3, 16252928
  s_load_dwordx2 s[100:101], s[52:53], s3
  buffer_load_dwordx4 v32, s[24:27], s65 offen offset:0 lds
  buffer_load_dwordx4 v33, s[24:27], s65 offen offset:1024 lds
  buffer_load_dwordx4 v34, s[24:27], s65 offen offset:2048 lds
  buffer_load_dwordx4 v35, s[24:27], s65 offen offset:3072 lds
  s_add_u32 m0, m0, 16384
  s_add_u32 s65, s65, 128
  s_and_b32 s65, s65, 0x3ff
  buffer_load_dwordx4 v32, s[24:27], s65 offen offset:0 lds
  buffer_load_dwordx4 v33, s[24:27], s65 offen offset:1024 lds
  buffer_load_dwordx4 v34, s[24:27], s65 offen offset:2048 lds
  buffer_load_dwordx4 v35, s[24:27], s65 offen offset:3072 lds
  s_add_u32 m0, m0, 16384
  s_add_u32 s65, s65, 128
  s_and_b32 s65, s65, 0x3ff
  buffer_load_dwordx4 v32, s[24:27], s65 offen offset:0 lds
  buffer_load_dwordx4 v33, s[24:27], s65 offen offset:1024 lds
  buffer_load_dwordx4 v34, s[24:27], s65 offen offset:2048 lds
  buffer_load_dwordx4 v35, s[24:27], s65 offen offset:3072 lds
  s_add_u32 m0, m0, 16384
  s_add_u32 s65, s65, 128
  s_and_b32 s65, s65, 0x3ff
  buffer_load_dwordx4 v32, s[24:27], s65 offen offset:0 lds
  buffer_load_dwordx4 v33, s[24:27], s65 offen offset:1024 lds
  buffer_load_dwordx4 v34, s[24:27], s65 offen offset:2048 lds
  buffer_load_dwordx4 v35, s[24:27], s65 offen offset:3072 lds
  s_add_u32 m0, m0, 16384
  s_add_u32 s65, s65, 128
  s_and_b32 s65, s65, 0x3ff
  v_and_b32 v10, 31, v0
  v_lshrrev_b32 v11, 5, v0
  v_bfe_u32 v4, v0, 1, 3
  v_xor_b32 v4, v4, v11
  v_lshlrev_b32 v4, 4, v4
  v_lshl_add_u32 v4, v10, 7, v4
  v_add_u32 v36, s64, v4
  v_xor_b32 v37, 32, v36
  v_xor_b32 v38, 64, v36
  v_xor_b32 v39, 0x60, v36
  v_mov_b32 v40, 0
  v_mov_b32 v41, 0
  v_mov_b32 v42, 0
  v_mov_b32 v43, 0
  s_mov_b32 s66, 0x3f803f80
  s_mov_b32 s67, 0xffff0000
  v_bfe_u32 v12, v0, 2, 2
  v_lshl_add_u32 v13, v11, 3, v12
  v_bfe_u32 v14, v0, 4, 1
  v_bfe_u32 v15, v0, 1, 1
  v_lshl_add_u32 v2, v14, 1, v15
  v_lshrrev_b32 v3, 1, v12
  v_lshlrev_b32 v3, 2, v3
  v_xor_b32 v2, v2, v3
  v_lshlrev_b32 v2, 4, v2
  v_and_b32 v3, 1, v0
  v_lshl_add_u32 v2, v3, 3, v2
  v_lshl_add_u32 v2, v13, 7, v2
  v_and_b32 v4, 3, v0
  v_lshlrev_b32 v4, 3, v4
  v_lshl_add_u32 v4, v14, 5, v4
  v_lshl_add_u32 v4, v13, 6, v4
  v_add_u32 v4, 2048, v4
  v_mul_u32_u24 v5, 192, v13
  v_lshl_add_u32 v5, v3, 3, v5
  v_lshl_add_u32 v5, v15, 4, v5
  v_mul_u32_u24 v6, 3072, v14
  v_add_u32 v5, v5, v6
  v_add_u32 v5, 114688, v5
  v_lshlrev_b32 v7, 5, v14
  v_sub_u32 v6, v5, v7
  v_add_u32 v6, 32, v6
  v_add_u32 v5, v5, v7
  v_xor_b32 v3, 64, v2
  v_and_b32 v9, 15, v0
  v_lshl_add_u32 v9, v11, 4, v9
  v_lshlrev_b32 v9, 4, v9
  v_mul_u32_u24 v7, 3, v14
  v_lshl_add_u32 v9, v7, 16, v9
  v_add_u32 v9, 1024, v9
  s_and_b32 s62, s60, 7
  s_lshl_b32 s62, s62, 8
  s_add_u32 s62, s62, s63
  s_mul_i32 s68, s62, 3072
  s_cmp_lt_u32 s60, 8
  s_cselect_b32 s62, 2048, 0
  s_cselect_b32 s72, 0x3eb8aa3b, 1.0
  s_add_u32 s68, s68, s62
  s_add_u32 s69, s68, 196608
  s_add_u32 s70, s69, 196608
  s_add_u32 s71, s70, 196608
  s_lshl_b32 s62, s60, 7
  s_add_u32 s62, s62, s63
  s_mul_i32 s73, s62, 3072
  s_mul_i32 s62, s60, 6
  s_min_u32 s62, s62, 80
  s_mul_i32 s74, s63, 86
  s_add_u32 s74, s74, s62
  s_lshl_b32 s74, s74, 10
  s_add_u32 s74, s74, 6291456
  s_add_u32 s75, s74, 4096
  s_cmp_ge_u32 s60, 14
  s_cselect_b32 s74, 16777216, s74
  s_cmp_ge_u32 s60, 15
  s_cselect_b32 s75, 16777216, s75
  s_waitcnt vmcnt(12)
  ds_read_b128 v[128:131], v36 offset:0
  ds_read_b128 v[132:135], v37 offset:0
  ds_read_b128 v[136:139], v38 offset:0
  ds_read_b128 v[140:143], v39 offset:0
  buffer_load_dwordx4 v32, s[24:27], s65 offen offset:0 lds
  buffer_load_dwordx4 v33, s[24:27], s65 offen offset:1024 lds
  buffer_load_dwordx4 v34, s[24:27], s65 offen offset:2048 lds
  buffer_load_dwordx4 v35, s[24:27], s65 offen offset:3072 lds
  s_add_u32 m0, m0, 16384
  s_add_u32 s65, s65, 128
  s_and_b32 s65, s65, 0x3ff
  s_waitcnt lgkmcnt(0)
  s_add_u32 s100, s100, 2135587861
  s_addc_u32 s101, s101, 2654435769
  s_waitcnt vmcnt(12)
  ds_read_b128 v[144:147], v36 offset:16384
  ds_read_b128 v[148:151], v37 offset:16384
  ds_read_b128 v[152:155], v38 offset:16384
  ds_read_b128 v[156:159], v39 offset:16384
  buffer_load_dwordx4 v32, s[24:27], s65 offen offset:0 lds
  buffer_load_dwordx4 v33, s[24:27], s65 offen offset:1024 lds
  buffer_load_dwordx4 v34, s[24:27], s65 offen offset:2048 lds
  buffer_load_dwordx4 v35, s[24:27], s65 offen offset:3072 lds
  s_add_u32 m0, m0, 16384
  s_add_u32 s65, s65, 128
  s_and_b32 s65, s65, 0x3ff
  v_dot2c_f32_bf16 v40, s66, v128
  v_dot2c_f32_bf16 v42, v128, v128
  v_dot2c_f32_bf16 v41, s66, v129
  v_dot2c_f32_bf16 v43, v129, v129
  v_dot2c_f32_bf16 v40, s66, v130
  v_dot2c_f32_bf16 v42, v130, v130
  v_dot2c_f32_bf16 v41, s66, v131
  v_dot2c_f32_bf16 v43, v131, v131
  v_dot2c_f32_bf16 v40, s66, v132
  v_dot2c_f32_bf16 v42, v132, v132
  v_dot2c_f32_bf16 v41, s66, v133
  v_dot2c_f32_bf16 v43, v133, v133
  v_dot2c_f32_bf16 v40, s66, v134
  v_dot2c_f32_bf16 v42, v134, v134
  v_dot2c_f32_bf16 v41, s66, v135
  v_dot2c_f32_bf16 v43, v135, v135
  v_dot2c_f32_bf16 v40, s66, v136
  v_dot2c_f32_bf16 v42, v136, v136
  v_dot2c_f32_bf16 v41, s66, v137
  v_dot2c_f32_bf16 v43, v137, v137
  v_dot2c_f32_bf16 v40, s66, v138
  v_dot2c_f32_bf16 v42, v138, v138
  v_dot2c_f32_bf16 v41, s66, v139
  v_dot2c_f32_bf16 v43, v139, v139
  v_dot2c_f32_bf16 v40, s66, v140
  v_dot2c_f32_bf16 v42, v140, v140
  v_dot2c_f32_bf16 v41, s66, v141
  v_dot2c_f32_bf16 v43, v141, v141
  v_dot2c_f32_bf16 v40, s66, v142
  v_dot2c_f32_bf16 v42, v142, v142
  v_dot2c_f32_bf16 v41, s66, v143
  v_dot2c_f32_bf16 v43, v143, v143
  s_waitcnt lgkmcnt(0)
  s_waitcnt vmcnt(12)
  ds_read_b128 v[160:163], v36 offset:32768
  ds_read_b128 v[164:167], v37 offset:32768
  ds_read_b128 v[168:171], v38 offset:32768
  ds_read_b128 v[172:175], v39 offset:32768
  buffer_load_dwordx4 v32, s[24:27], s65 offen offset:0 lds
  buffer_load_dwordx4 v33, s[24:27], s65 offen offset:1024 lds
  buffer_load_dwordx4 v34, s[24:27], s65 offen offset:2048 lds
  buffer_load_dwordx4 v35, s[24:27], s65 offen offset:3072 lds
  s_add_u32 m0, m0, 16384
  s_add_u32 s65, s65, 128
  s_and_b32 s65, s65, 0x3ff
  v_dot2c_f32_bf16 v40, s66, v144
  v_dot2c_f32_bf16 v42, v144, v144
  v_dot2c_f32_bf16 v41, s66, v145
  v_dot2c_f32_bf16 v43, v145, v145
  v_dot2c_f32_bf16 v40, s66, v146
  v_dot2c_f32_bf16 v42, v146, v146
  v_dot2c_f32_bf16 v41, s66, v147
  v_dot2c_f32_bf16 v43, v147, v147
  v_dot2c_f32_bf16 v40, s66, v148
  v_dot2c_f32_bf16 v42, v148, v148
  v_dot2c_f32_bf16 v41, s66, v149
  v_dot2c_f32_bf16 v43, v149, v149
  v_dot2c_f32_bf16 v40, s66, v150
  v_dot2c_f32_bf16 v42, v150, v150
  v_dot2c_f32_bf16 v41, s66, v151
  v_dot2c_f32_bf16 v43, v151, v151
  v_dot2c_f32_bf16 v40, s66, v152
  v_dot2c_f32_bf16 v42, v152, v152
  v_dot2c_f32_bf16 v41, s66, v153
  v_dot2c_f32_bf16 v43, v153, v153
  v_dot2c_f32_bf16 v40, s66, v154
  v_dot2c_f32_bf16 v42, v154, v154
  v_dot2c_f32_bf16 v41, s66, v155
  v_dot2c_f32_bf16 v43, v155, v155
  v_dot2c_f32_bf16 v40, s66, v156
  v_dot2c_f32_bf16 v42, v156, v156
  v_dot2c_f32_bf16 v41, s66, v157
  v_dot2c_f32_bf16 v43, v157, v157
  v_dot2c_f32_bf16 v40, s66, v158
  v_dot2c_f32_bf16 v42, v158, v158
  v_dot2c_f32_bf16 v41, s66, v159
  v_dot2c_f32_bf16 v43, v159, v159
  s_waitcnt lgkmcnt(0)
  s_waitcnt vmcnt(12)
  ds_read_b128 v[176:179], v36 offset:49152
  ds_read_b128 v[180:183], v37 offset:49152
  ds_read_b128 v[184:187], v38 offset:49152
  ds_read_b128 v[188:191], v39 offset:49152
  buffer_load_dwordx4 v32, s[24:27], s65 offen offset:0 lds
  buffer_load_dwordx4 v33, s[24:27], s65 offen offset:1024 lds
  buffer_load_dwordx4 v34, s[24:27], s65 offen offset:2048 lds
  buffer_load_dwordx4 v35, s[24:27], s65 offen offset:3072 lds
  s_add_u32 m0, m0, 16384
  s_add_u32 s65, s65, 128
  s_and_b32 s65, s65, 0x3ff
  v_dot2c_f32_bf16 v40, s66, v160
  v_dot2c_f32_bf16 v42, v160, v160
  v_dot2c_f32_bf16 v41, s66, v161
  v_dot2c_f32_bf16 v43, v161, v161
  v_dot2c_f32_bf16 v40, s66, v162
  v_dot2c_f32_bf16 v42, v162, v162
  v_dot2c_f32_bf16 v41, s66, v163
  v_dot2c_f32_bf16 v43, v163, v163
  v_dot2c_f32_bf16 v40, s66, v164
  v_dot2c_f32_bf16 v42, v164, v164
  v_dot2c_f32_bf16 v41, s66, v165
  v_dot2c_f32_bf16 v43, v165, v165
  v_dot2c_f32_bf16 v40, s66, v166
  v_dot2c_f32_bf16 v42, v166, v166
  v_dot2c_f32_bf16 v41, s66, v167
  v_dot2c_f32_bf16 v43, v167, v167
  v_dot2c_f32_bf16 v40, s66, v168
  v_dot2c_f32_bf16 v42, v168, v168
  v_dot2c_f32_bf16 v41, s66, v169
  v_dot2c_f32_bf16 v43, v169, v169
  v_dot2c_f32_bf16 v40, s66, v170
  v_dot2c_f32_bf16 v42, v170, v170
  v_dot2c_f32_bf16 v41, s66, v171
  v_dot2c_f32_bf16 v43, v171, v171
  v_dot2c_f32_bf16 v40, s66, v172
  v_dot2c_f32_bf16 v42, v172, v172
  v_dot2c_f32_bf16 v41, s66, v173
  v_dot2c_f32_bf16 v43, v173, v173
  v_dot2c_f32_bf16 v40, s66, v174
  v_dot2c_f32_bf16 v42, v174, v174
  v_dot2c_f32_bf16 v41, s66, v175
  v_dot2c_f32_bf16 v43, v175, v175
  s_waitcnt lgkmcnt(0)
  s_barrier
  s_waitcnt vmcnt(12)
  v_add_u32 v36, 0x10000, v36
  v_add_u32 v37, 0x10000, v37
  v_add_u32 v38, 0x10000, v38
  v_add_u32 v39, 0x10000, v39
  ds_read_b128 v[192:195], v36 offset:0
  ds_read_b128 v[196:199], v37 offset:0
  ds_read_b128 v[200:203], v38 offset:0
  ds_read_b128 v[204:207], v39 offset:0
  v_dot2c_f32_bf16 v40, s66, v176
  v_dot2c_f32_bf16 v42, v176, v176
  v_dot2c_f32_bf16 v41, s66, v177
  v_dot2c_f32_bf16 v43, v177, v177
  v_dot2c_f32_bf16 v40, s66, v178
  v_dot2c_f32_bf16 v42, v178, v178
  v_dot2c_f32_bf16 v41, s66, v179
  v_dot2c_f32_bf16 v43, v179, v179
  v_dot2c_f32_bf16 v40, s66, v180
  v_dot2c_f32_bf16 v42, v180, v180
  v_dot2c_f32_bf16 v41, s66, v181
  v_dot2c_f32_bf16 v43, v181, v181
  v_dot2c_f32_bf16 v40, s66, v182
  v_dot2c_f32_bf16 v42, v182, v182
  v_dot2c_f32_bf16 v41, s66, v183
  v_dot2c_f32_bf16 v43, v183, v183
  v_dot2c_f32_bf16 v40, s66, v184
  v_dot2c_f32_bf16 v42, v184, v184
  v_dot2c_f32_bf16 v41, s66, v185
  v_dot2c_f32_bf16 v43, v185, v185
  v_dot2c_f32_bf16 v40, s66, v186
  v_dot2c_f32_bf16 v42, v186, v186
  v_dot2c_f32_bf16 v41, s66, v187
  v_dot2c_f32_bf16 v43, v187, v187
  v_dot2c_f32_bf16 v40, s66, v188
  v_dot2c_f32_bf16 v42, v188, v188
  v_dot2c_f32_bf16 v41, s66, v189
  v_dot2c_f32_bf16 v43, v189, v189
  v_dot2c_f32_bf16 v40, s66, v190
  v_dot2c_f32_bf16 v42, v190, v190
  v_dot2c_f32_bf16 v41, s66, v191
  v_dot2c_f32_bf16 v43, v191, v191
  s_waitcnt lgkmcnt(0)
  s_waitcnt vmcnt(8)
  ds_read_b128 v[208:211], v36 offset:16384
  ds_read_b128 v[212:215], v37 offset:16384
  ds_read_b128 v[216:219], v38 offset:16384
  ds_read_b128 v[220:223], v39 offset:16384
  v_dot2c_f32_bf16 v40, s66, v192
  v_dot2c_f32_bf16 v42, v192, v192
  v_dot2c_f32_bf16 v41, s66, v193
  v_dot2c_f32_bf16 v43, v193, v193
  v_dot2c_f32_bf16 v40, s66, v194
  v_dot2c_f32_bf16 v42, v194, v194
  v_dot2c_f32_bf16 v41, s66, v195
  v_dot2c_f32_bf16 v43, v195, v195
  v_dot2c_f32_bf16 v40, s66, v196
  v_dot2c_f32_bf16 v42, v196, v196
  v_dot2c_f32_bf16 v41, s66, v197
  v_dot2c_f32_bf16 v43, v197, v197
  v_dot2c_f32_bf16 v40, s66, v198
  v_dot2c_f32_bf16 v42, v198, v198
  v_dot2c_f32_bf16 v41, s66, v199
  v_dot2c_f32_bf16 v43, v199, v199
  v_dot2c_f32_bf16 v40, s66, v200
  v_dot2c_f32_bf16 v42, v200, v200
  v_dot2c_f32_bf16 v41, s66, v201
  v_dot2c_f32_bf16 v43, v201, v201
  v_dot2c_f32_bf16 v40, s66, v202
  v_dot2c_f32_bf16 v42, v202, v202
  v_dot2c_f32_bf16 v41, s66, v203
  v_dot2c_f32_bf16 v43, v203, v203
  v_dot2c_f32_bf16 v40, s66, v204
  v_dot2c_f32_bf16 v42, v204, v204
  v_dot2c_f32_bf16 v41, s66, v205
  v_dot2c_f32_bf16 v43, v205, v205
  v_dot2c_f32_bf16 v40, s66, v206
  v_dot2c_f32_bf16 v42, v206, v206
  v_dot2c_f32_bf16 v41, s66, v207
  v_dot2c_f32_bf16 v43, v207, v207
  s_waitcnt lgkmcnt(0)
  s_waitcnt vmcnt(4)
  ds_read_b128 v[224:227], v36 offset:32768
  ds_read_b128 v[228:231], v37 offset:32768
  ds_read_b128 v[232:235], v38 offset:32768
  ds_read_b128 v[236:239], v39 offset:32768
  v_dot2c_f32_bf16 v40, s66, v208
  v_dot2c_f32_bf16 v42, v208, v208
  v_dot2c_f32_bf16 v41, s66, v209
  v_dot2c_f32_bf16 v43, v209, v209
  v_dot2c_f32_bf16 v40, s66, v210
  v_dot2c_f32_bf16 v42, v210, v210
  v_dot2c_f32_bf16 v41, s66, v211
  v_dot2c_f32_bf16 v43, v211, v211
  v_dot2c_f32_bf16 v40, s66, v212
  v_dot2c_f32_bf16 v42, v212, v212
  v_dot2c_f32_bf16 v41, s66, v213
  v_dot2c_f32_bf16 v43, v213, v213
  v_dot2c_f32_bf16 v40, s66, v214
  v_dot2c_f32_bf16 v42, v214, v214
  v_dot2c_f32_bf16 v41, s66, v215
  v_dot2c_f32_bf16 v43, v215, v215
  v_dot2c_f32_bf16 v40, s66, v216
  v_dot2c_f32_bf16 v42, v216, v216
  v_dot2c_f32_bf16 v41, s66, v217
  v_dot2c_f32_bf16 v43, v217, v217
  v_dot2c_f32_bf16 v40, s66, v218
  v_dot2c_f32_bf16 v42, v218, v218
  v_dot2c_f32_bf16 v41, s66, v219
  v_dot2c_f32_bf16 v43, v219, v219
  v_dot2c_f32_bf16 v40, s66, v220
  v_dot2c_f32_bf16 v42, v220, v220
  v_dot2c_f32_bf16 v41, s66, v221
  v_dot2c_f32_bf16 v43, v221, v221
  v_dot2c_f32_bf16 v40, s66, v222
  v_dot2c_f32_bf16 v42, v222, v222
  v_dot2c_f32_bf16 v41, s66, v223
  v_dot2c_f32_bf16 v43, v223, v223
  s_waitcnt lgkmcnt(0)
  s_waitcnt vmcnt(0)
  ds_read_b128 v[240:243], v36 offset:49152
  ds_read_b128 v[244:247], v37 offset:49152
  ds_read_b128 v[248:251], v38 offset:49152
  ds_read_b128 v[252:255], v39 offset:49152
  v_dot2c_f32_bf16 v40, s66, v224
  v_dot2c_f32_bf16 v42, v224, v224
  v_dot2c_f32_bf16 v41, s66, v225
  v_dot2c_f32_bf16 v43, v225, v225
  v_dot2c_f32_bf16 v40, s66, v226
  v_dot2c_f32_bf16 v42, v226, v226
  v_dot2c_f32_bf16 v41, s66, v227
  v_dot2c_f32_bf16 v43, v227, v227
  v_dot2c_f32_bf16 v40, s66, v228
  v_dot2c_f32_bf16 v42, v228, v228
  v_dot2c_f32_bf16 v41, s66, v229
  v_dot2c_f32_bf16 v43, v229, v229
  v_dot2c_f32_bf16 v40, s66, v230
  v_dot2c_f32_bf16 v42, v230, v230
  v_dot2c_f32_bf16 v41, s66, v231
  v_dot2c_f32_bf16 v43, v231, v231
  v_dot2c_f32_bf16 v40, s66, v232
  v_dot2c_f32_bf16 v42, v232, v232
  v_dot2c_f32_bf16 v41, s66, v233
  v_dot2c_f32_bf16 v43, v233, v233
  v_dot2c_f32_bf16 v40, s66, v234
  v_dot2c_f32_bf16 v42, v234, v234
  v_dot2c_f32_bf16 v41, s66, v235
  v_dot2c_f32_bf16 v43, v235, v235
  v_dot2c_f32_bf16 v40, s66, v236
  v_dot2c_f32_bf16 v42, v236, v236
  v_dot2c_f32_bf16 v41, s66, v237
  v_dot2c_f32_bf16 v43, v237, v237
  v_dot2c_f32_bf16 v40, s66, v238
  v_dot2c_f32_bf16 v42, v238, v238
  v_dot2c_f32_bf16 v41, s66, v239
  v_dot2c_f32_bf16 v43, v239, v239
  s_waitcnt lgkmcnt(0)
  s_barrier
  ds_read_b64_tr_b16 v[48:49], v2 offset:0
  ds_read_b64_tr_b16 v[50:51], v2 offset:512
  ds_read_b64_tr_b16 v[52:53], v3 offset:0
  ds_read_b64_tr_b16 v[54:55], v3 offset:512
  ds_read_b64_tr_b16 v[56:57], v4 offset:0
  ds_read_b64_tr_b16 v[58:59], v4 offset:256
  ds_read_b64_tr_b16 v[60:61], v2 offset:3072
  ds_read_b64_tr_b16 v[62:63], v2 offset:3584
  ds_read_b64_tr_b16 v[16:17], v3 offset:3072
  ds_read_b64_tr_b16 v[18:19], v3 offset:3584
  ds_read_b64_tr_b16 v[20:21], v4 offset:3072
  ds_read_b64_tr_b16 v[22:23], v4 offset:3328
  v_dot2c_f32_bf16 v40, s66, v240
  v_dot2c_f32_bf16 v42, v240, v240
  v_dot2c_f32_bf16 v41, s66, v241
  v_dot2c_f32_bf16 v43, v241, v241
  v_dot2c_f32_bf16 v40, s66, v242
  v_dot2c_f32_bf16 v42, v242, v242
  v_dot2c_f32_bf16 v41, s66, v243
  v_dot2c_f32_bf16 v43, v243, v243
  v_dot2c_f32_bf16 v40, s66, v244
  v_dot2c_f32_bf16 v42, v244, v244
  v_dot2c_f32_bf16 v41, s66, v245
  v_dot2c_f32_bf16 v43, v245, v245
  v_dot2c_f32_bf16 v40, s66, v246
  v_dot2c_f32_bf16 v42, v246, v246
  v_dot2c_f32_bf16 v41, s66, v247
  v_dot2c_f32_bf16 v43, v247, v247
  v_dot2c_f32_bf16 v40, s66, v248
  v_dot2c_f32_bf16 v42, v248, v248
  v_dot2c_f32_bf16 v41, s66, v249
  v_dot2c_f32_bf16 v43, v249, v249
  v_dot2c_f32_bf16 v40, s66, v250
  v_dot2c_f32_bf16 v42, v250, v250
  v_dot2c_f32_bf16 v41, s66, v251
  v_dot2c_f32_bf16 v43, v251, v251
  v_dot2c_f32_bf16 v40, s66, v252
  v_dot2c_f32_bf16 v42, v252, v252
  v_dot2c_f32_bf16 v41, s66, v253
  v_dot2c_f32_bf16 v43, v253, v253
  v_dot2c_f32_bf16 v40, s66, v254
  v_dot2c_f32_bf16 v42, v254, v254
  v_dot2c_f32_bf16 v41, s66, v255
  v_dot2c_f32_bf16 v43, v255, v255
  s_nop 1
  v_add_f32 v40, v40, v41
  v_add_f32 v42, v42, v43
  v_mov_b32 v41, v40
  v_mov_b32 v43, v42
  s_nop 0
  v_permlane32_swap_b32 v40, v41
  v_permlane32_swap_b32 v42, v43
  v_add_f32 v40, v40, v41
  v_add_f32 v42, v42, v43
  v_mul_f32 v40, 0x3b000000, v40
  v_mul_f32 v42, 0x3b000000, v42
  v_fma_f32 v42, -v40, v40, v42
  v_max_f32 v42, 0, v42
  v_add_f32 v42, 0x3727c5ac, v42
  v_rsq_f32 v7, v42
  s_nop 0
  v_mul_f32_e64 v8, -v40, v7
  v_lshlrev_b32 v10, 16, v128
  v_and_b32 v11, s67, v128
  v_lshlrev_b32 v12, 16, v129
  v_and_b32 v13, s67, v129
  v_fma_f32 v10, v10, v7, v8
  v_fma_f32 v11, v11, v7, v8
  v_fma_f32 v12, v12, v7, v8
  v_fma_f32 v13, v13, v7, v8
  v_cvt_pk_bf16_f32 v128, v10, v11
  v_cvt_pk_bf16_f32 v129, v12, v13
  v_lshlrev_b32 v10, 16, v130
  v_and_b32 v11, s67, v130
  v_lshlrev_b32 v12, 16, v131
  v_and_b32 v13, s67, v131
  v_fma_f32 v10, v10, v7, v8
  v_fma_f32 v11, v11, v7, v8
  v_fma_f32 v12, v12, v7, v8
  v_fma_f32 v13, v13, v7, v8
  v_cvt_pk_bf16_f32 v130, v10, v11
  v_cvt_pk_bf16_f32 v131, v12, v13
  s_waitcnt lgkmcnt(10)
  s_nop 0
  v_mfma_f32_32x32x16_bf16 v[80:95], v[48:51], v[128:131], 0
  ds_read_b64_tr_b16 v[48:49], v2 offset:6144
  ds_read_b64_tr_b16 v[50:51], v2 offset:6656
  v_lshlrev_b32 v10, 16, v132
  v_and_b32 v11, s67, v132
  v_lshlrev_b32 v12, 16, v133
  v_and_b32 v13, s67, v133
  v_fma_f32 v10, v10, v7, v8
  v_fma_f32 v11, v11, v7, v8
  v_fma_f32 v12, v12, v7, v8
  s_waitcnt lgkmcnt(10)
  v_mfma_f32_32x32x16_bf16 v[96:111], v[52:55], v[128:131], 0
  ds_read_b64_tr_b16 v[52:53], v3 offset:6144
  ds_read_b64_tr_b16 v[54:55], v3 offset:6656
  v_fma_f32 v13, v13, v7, v8
  v_cvt_pk_bf16_f32 v132, v10, v11
  v_cvt_pk_bf16_f32 v133, v12, v13
  v_lshlrev_b32 v10, 16, v134
  v_and_b32 v11, s67, v134
  v_lshlrev_b32 v12, 16, v135
  v_and_b32 v13, s67, v135
  s_waitcnt lgkmcnt(10)
  v_mfma_f32_32x32x16_bf16 v[112:127], v[128:131], v[56:59], 0
  v_fma_f32 v10, v10, v7, v8
  v_fma_f32 v11, v11, v7, v8
  v_fma_f32 v12, v12, v7, v8
  v_fma_f32 v13, v13, v7, v8
  v_cvt_pk_bf16_f32 v134, v10, v11
  v_cvt_pk_bf16_f32 v135, v12, v13
  ds_read_b64_tr_b16 v[56:57], v4 offset:6144
  ds_read_b64_tr_b16 v[58:59], v4 offset:6400
  s_waitcnt lgkmcnt(10)
  v_mfma_f32_32x32x16_bf16 v[80:95], v[60:63], v[132:135], v[80:95]
  ds_read_b64_tr_b16 v[60:61], v2 offset:9216
  ds_read_b64_tr_b16 v[62:63], v2 offset:9728
  v_lshlrev_b32 v10, 16, v136
  v_and_b32 v11, s67, v136
  v_lshlrev_b32 v12, 16, v137
  v_and_b32 v13, s67, v137
  v_fma_f32 v10, v10, v7, v8
  v_fma_f32 v11, v11, v7, v8
  v_fma_f32 v12, v12, v7, v8
  s_waitcnt lgkmcnt(10)
  v_mfma_f32_32x32x16_bf16 v[96:111], v[16:19], v[132:135], v[96:111]
  ds_read_b64_tr_b16 v[24:25], v3 offset:9216
  ds_read_b64_tr_b16 v[26:27], v3 offset:9728
  v_fma_f32 v13, v13, v7, v8
  v_cvt_pk_bf16_f32 v136, v10, v11
  v_cvt_pk_bf16_f32 v137, v12, v13
  v_lshlrev_b32 v10, 16, v138
  v_and_b32 v11, s67, v138
  v_lshlrev_b32 v12, 16, v139
  v_and_b32 v13, s67, v139
  s_waitcnt lgkmcnt(10)
  v_mfma_f32_32x32x16_bf16 v[112:127], v[132:135], v[20:23], v[112:127]
  v_fma_f32 v10, v10, v7, v8
  v_fma_f32 v11, v11, v7, v8
  v_fma_f32 v12, v12, v7, v8
  v_fma_f32 v13, v13, v7, v8
  v_cvt_pk_bf16_f32 v138, v10, v11
  v_cvt_pk_bf16_f32 v139, v12, v13
  ds_read_b64_tr_b16 v[28:29], v4 offset:9216
  ds_read_b64_tr_b16 v[30:31], v4 offset:9472
  s_waitcnt lgkmcnt(10)
  v_mfma_f32_32x32x16_bf16 v[80:95], v[48:51], v[136:139], v[80:95]
  s_barrier
  ds_read_b64_tr_b16 v[48:49], v2 offset:12288
  ds_read_b64_tr_b16 v[50:51], v2 offset:12800
  v_lshlrev_b32 v10, 16, v140
  v_and_b32 v11, s67, v140
  v_lshlrev_b32 v12, 16, v141
  v_and_b32 v13, s67, v141
  v_fma_f32 v10, v10, v7, v8
  v_fma_f32 v11, v11, v7, v8
  v_fma_f32 v12, v12, v7, v8
  s_waitcnt lgkmcnt(10)
  v_mfma_f32_32x32x16_bf16 v[96:111], v[52:55], v[136:139], v[96:111]
  ds_read_b64_tr_b16 v[52:53], v3 offset:12288
  ds_read_b64_tr_b16 v[54:55], v3 offset:12800
  v_fma_f32 v13, v13, v7, v8
  v_cvt_pk_bf16_f32 v140, v10, v11
  v_cvt_pk_bf16_f32 v141, v12, v13
  v_lshlrev_b32 v10, 16, v142
  v_and_b32 v11, s67, v142
  v_lshlrev_b32 v12, 16, v143
  v_and_b32 v13, s67, v143
  s_waitcnt lgkmcnt(10)
  v_mfma_f32_32x32x16_bf16 v[112:127], v[136:139], v[56:59], v[112:127]
  v_fma_f32 v10, v10, v7, v8
  v_fma_f32 v11, v11, v7, v8
  v_fma_f32 v12, v12, v7, v8
  v_fma_f32 v13, v13, v7, v8
  v_cvt_pk_bf16_f32 v142, v10, v11
  v_cvt_pk_bf16_f32 v143, v12, v13
  ds_read_b64_tr_b16 v[56:57], v4 offset:12288
  ds_read_b64_tr_b16 v[58:59], v4 offset:12544
  s_waitcnt lgkmcnt(10)
  v_mfma_f32_32x32x16_bf16 v[80:95], v[60:63], v[140:143], v[80:95]
  ds_read_b64_tr_b16 v[60:61], v2 offset:15360
  ds_read_b64_tr_b16 v[62:63], v2 offset:15872
  v_lshlrev_b32 v10, 16, v144
  v_and_b32 v11, s67, v144
  v_lshlrev_b32 v12, 16, v145
  v_and_b32 v13, s67, v145
  v_fma_f32 v10, v10, v7, v8
  v_fma_f32 v11, v11, v7, v8
  v_fma_f32 v12, v12, v7, v8
  s_waitcnt lgkmcnt(10)
  v_mfma_f32_32x32x16_bf16 v[96:111], v[24:27], v[140:143], v[96:111]
  ds_read_b64_tr_b16 v[16:17], v3 offset:15360
  ds_read_b64_tr_b16 v[18:19], v3 offset:15872
  v_fma_f32 v13, v13, v7, v8
  v_cvt_pk_bf16_f32 v144, v10, v11
  v_cvt_pk_bf16_f32 v145, v12, v13
  v_lshlrev_b32 v10, 16, v146
  v_and_b32 v11, s67, v146
  v_lshlrev_b32 v12, 16, v147
  v_and_b32 v13, s67, v147
  s_waitcnt lgkmcnt(10)
  v_mfma_f32_32x32x16_bf16 v[112:127], v[140:143], v[28:31], v[112:127]
  v_fma_f32 v10, v10, v7, v8
  v_fma_f32 v11, v11, v7, v8
  v_fma_f32 v12, v12, v7, v8
  v_fma_f32 v13, v13, v7, v8
  v_cvt_pk_bf16_f32 v146, v10, v11
  v_cvt_pk_bf16_f32 v147, v12, v13
  ds_read_b64_tr_b16 v[20:21], v4 offset:15360
  ds_read_b64_tr_b16 v[22:23], v4 offset:15616
  s_waitcnt lgkmcnt(10)
  v_mfma_f32_32x32x16_bf16 v[80:95], v[48:51], v[144:147], v[80:95]
  ds_read_b64_tr_b16 v[48:49], v2 offset:18432
  ds_read_b64_tr_b16 v[50:51], v2 offset:18944
  v_lshlrev_b32 v10, 16, v148
  v_and_b32 v11, s67, v148
  v_lshlrev_b32 v12, 16, v149
  v_and_b32 v13, s67, v149
  v_fma_f32 v10, v10, v7, v8
  v_fma_f32 v11, v11, v7, v8
  v_fma_f32 v12, v12, v7, v8
  s_waitcnt lgkmcnt(10)
  v_mfma_f32_32x32x16_bf16 v[96:111], v[52:55], v[144:147], v[96:111]
  ds_read_b64_tr_b16 v[52:53], v3 offset:18432
  ds_read_b64_tr_b16 v[54:55], v3 offset:18944
  v_fma_f32 v13, v13, v7, v8
  v_cvt_pk_bf16_f32 v148, v10, v11
  v_cvt_pk_bf16_f32 v149, v12, v13
  v_lshlrev_b32 v10, 16, v150
  v_and_b32 v11, s67, v150
  v_lshlrev_b32 v12, 16, v151
  v_and_b32 v13, s67, v151
  s_waitcnt lgkmcnt(10)
  v_mfma_f32_32x32x16_bf16 v[112:127], v[144:147], v[56:59], v[112:127]
  v_fma_f32 v10, v10, v7, v8
  v_fma_f32 v11, v11, v7, v8
  v_fma_f32 v12, v12, v7, v8
  v_fma_f32 v13, v13, v7, v8
  v_cvt_pk_bf16_f32 v150, v10, v11
  v_cvt_pk_bf16_f32 v151, v12, v13
  ds_read_b64_tr_b16 v[56:57], v4 offset:18432
  ds_read_b64_tr_b16 v[58:59], v4 offset:18688
  s_waitcnt lgkmcnt(10)
  v_mfma_f32_32x32x16_bf16 v[80:95], v[60:63], v[148:151], v[80:95]
  ds_read_b64_tr_b16 v[60:61], v2 offset:21504
  ds_read_b64_tr_b16 v[62:63], v2 offset:22016
  v_lshlrev_b32 v10, 16, v152
  v_and_b32 v11, s67, v152
  v_lshlrev_b32 v12, 16, v153
  v_and_b32 v13, s67, v153
  v_fma_f32 v10, v10, v7, v8
  v_fma_f32 v11, v11, v7, v8
  v_fma_f32 v12, v12, v7, v8
  s_waitcnt lgkmcnt(10)
  v_mfma_f32_32x32x16_bf16 v[96:111], v[16:19], v[148:151], v[96:111]
  ds_read_b64_tr_b16 v[24:25], v3 offset:21504
  ds_read_b64_tr_b16 v[26:27], v3 offset:22016
  v_fma_f32 v13, v13, v7, v8
  v_cvt_pk_bf16_f32 v152, v10, v11
  v_cvt_pk_bf16_f32 v153, v12, v13
  v_lshlrev_b32 v10, 16, v154
  v_and_b32 v11, s67, v154
  v_lshlrev_b32 v12, 16, v155
  v_and_b32 v13, s67, v155
  s_waitcnt lgkmcnt(10)
  v_mfma_f32_32x32x16_bf16 v[112:127], v[148:151], v[20:23], v[112:127]
  v_fma_f32 v10, v10, v7, v8
  v_fma_f32 v11, v11, v7, v8
  v_fma_f32 v12, v12, v7, v8
  v_fma_f32 v13, v13, v7, v8
  v_cvt_pk_bf16_f32 v154, v10, v11
  v_cvt_pk_bf16_f32 v155, v12, v13
  ds_read_b64_tr_b16 v[28:29], v4 offset:21504
  ds_read_b64_tr_b16 v[30:31], v4 offset:21760
  s_waitcnt lgkmcnt(10)
  v_mfma_f32_32x32x16_bf16 v[80:95], v[48:51], v[152:155], v[80:95]
  s_barrier
  ds_read_b64_tr_b16 v[48:49], v2 offset:24576
  ds_read_b64_tr_b16 v[50:51], v2 offset:25088
  v_lshlrev_b32 v10, 16, v156
  v_and_b32 v11, s67, v156
  v_lshlrev_b32 v12, 16, v157
  v_and_b32 v13, s67, v157
  v_fma_f32 v10, v10, v7, v8
  v_fma_f32 v11, v11, v7, v8
  v_fma_f32 v12, v12, v7, v8
  s_waitcnt lgkmcnt(10)
  v_mfma_f32_32x32x16_bf16 v[96:111], v[52:55], v[152:155], v[96:111]
  ds_read_b64_tr_b16 v[52:53], v3 offset:24576
  ds_read_b64_tr_b16 v[54:55], v3 offset:25088
  v_fma_f32 v13, v13, v7, v8
  v_cvt_pk_bf16_f32 v156, v10, v11
  v_cvt_pk_bf16_f32 v157, v12, v13
  v_lshlrev_b32 v10, 16, v158
  v_and_b32 v11, s67, v158
  v_lshlrev_b32 v12, 16, v159
  v_and_b32 v13, s67, v159
  s_waitcnt lgkmcnt(10)
  v_mfma_f32_32x32x16_bf16 v[112:127], v[152:155], v[56:59], v[112:127]
  v_fma_f32 v10, v10, v7, v8
  v_fma_f32 v11, v11, v7, v8
  v_fma_f32 v12, v12, v7, v8
  v_fma_f32 v13, v13, v7, v8
  v_cvt_pk_bf16_f32 v158, v10, v11
  v_cvt_pk_bf16_f32 v159, v12, v13
  ds_read_b64_tr_b16 v[56:57], v4 offset:24576
  ds_read_b64_tr_b16 v[58:59], v4 offset:24832
  s_waitcnt lgkmcnt(10)
  v_mfma_f32_32x32x16_bf16 v[80:95], v[60:63], v[156:159], v[80:95]
  ds_read_b64_tr_b16 v[60:61], v2 offset:27648
  ds_read_b64_tr_b16 v[62:63], v2 offset:28160
  v_lshlrev_b32 v10, 16, v160
  v_and_b32 v11, s67, v160
  v_lshlrev_b32 v12, 16, v161
  v_and_b32 v13, s67, v161
  v_fma_f32 v10, v10, v7, v8
  v_fma_f32 v11, v11, v7, v8
  v_fma_f32 v12, v12, v7, v8
  s_waitcnt lgkmcnt(10)
  v_mfma_f32_32x32x16_bf16 v[96:111], v[24:27], v[156:159], v[96:111]
  ds_read_b64_tr_b16 v[16:17], v3 offset:27648
  ds_read_b64_tr_b16 v[18:19], v3 offset:28160
  v_fma_f32 v13, v13, v7, v8
  v_cvt_pk_bf16_f32 v160, v10, v11
  v_cvt_pk_bf16_f32 v161, v12, v13
  v_lshlrev_b32 v10, 16, v162
  v_and_b32 v11, s67, v162
  v_lshlrev_b32 v12, 16, v163
  v_and_b32 v13, s67, v163
  s_waitcnt lgkmcnt(10)
  v_mfma_f32_32x32x16_bf16 v[112:127], v[156:159], v[28:31], v[112:127]
  v_fma_f32 v10, v10, v7, v8
  v_fma_f32 v11, v11, v7, v8
  v_fma_f32 v12, v12, v7, v8
  v_fma_f32 v13, v13, v7, v8
  v_cvt_pk_bf16_f32 v162, v10, v11
  v_cvt_pk_bf16_f32 v163, v12, v13
  ds_read_b64_tr_b16 v[20:21], v4 offset:27648
  ds_read_b64_tr_b16 v[22:23], v4 offset:27904
  s_waitcnt lgkmcnt(10)
  v_mfma_f32_32x32x16_bf16 v[80:95], v[48:51], v[160:163], v[80:95]
  ds_read_b64_tr_b16 v[48:49], v2 offset:30720
  ds_read_b64_tr_b16 v[50:51], v2 offset:31232
  v_lshlrev_b32 v10, 16, v164
  v_and_b32 v11, s67, v164
  v_lshlrev_b32 v12, 16, v165
  v_and_b32 v13, s67, v165
  v_fma_f32 v10, v10, v7, v8
  v_fma_f32 v11, v11, v7, v8
  v_fma_f32 v12, v12, v7, v8
  s_waitcnt lgkmcnt(10)
  v_mfma_f32_32x32x16_bf16 v[96:111], v[52:55], v[160:163], v[96:111]
  ds_read_b64_tr_b16 v[52:53], v3 offset:30720
  ds_read_b64_tr_b16 v[54:55], v3 offset:31232
  v_fma_f32 v13, v13, v7, v8
  v_cvt_pk_bf16_f32 v164, v10, v11
  v_cvt_pk_bf16_f32 v165, v12, v13
  v_lshlrev_b32 v10, 16, v166
  v_and_b32 v11, s67, v166
  v_lshlrev_b32 v12, 16, v167
  v_and_b32 v13, s67, v167
  s_waitcnt lgkmcnt(10)
  v_mfma_f32_32x32x16_bf16 v[112:127], v[160:163], v[56:59], v[112:127]
  v_fma_f32 v10, v10, v7, v8
  v_fma_f32 v11, v11, v7, v8
  v_fma_f32 v12, v12, v7, v8
  v_fma_f32 v13, v13, v7, v8
  v_cvt_pk_bf16_f32 v166, v10, v11
  v_cvt_pk_bf16_f32 v167, v12, v13
  ds_read_b64_tr_b16 v[56:57], v4 offset:30720
  ds_read_b64_tr_b16 v[58:59], v4 offset:30976
  s_waitcnt lgkmcnt(10)
  v_mfma_f32_32x32x16_bf16 v[80:95], v[60:63], v[164:167], v[80:95]
  ds_read_b64_tr_b16 v[60:61], v2 offset:33792
  ds_read_b64_tr_b16 v[62:63], v2 offset:34304
  v_lshlrev_b32 v10, 16, v168
  v_and_b32 v11, s67, v168
  v_lshlrev_b32 v12, 16, v169
  v_and_b32 v13, s67, v169
  v_fma_f32 v10, v10, v7, v8
  v_fma_f32 v11, v11, v7, v8
  v_fma_f32 v12, v12, v7, v8
  s_waitcnt lgkmcnt(10)
  v_mfma_f32_32x32x16_bf16 v[96:111], v[16:19], v[164:167], v[96:111]
  ds_read_b64_tr_b16 v[24:25], v3 offset:33792
  ds_read_b64_tr_b16 v[26:27], v3 offset:34304
  v_fma_f32 v13, v13, v7, v8
  v_cvt_pk_bf16_f32 v168, v10, v11
  v_cvt_pk_bf16_f32 v169, v12, v13
  v_lshlrev_b32 v10, 16, v170
  v_and_b32 v11, s67, v170
  v_lshlrev_b32 v12, 16, v171
  v_and_b32 v13, s67, v171
  s_waitcnt lgkmcnt(10)
  v_mfma_f32_32x32x16_bf16 v[112:127], v[164:167], v[20:23], v[112:127]
  v_fma_f32 v10, v10, v7, v8
  v_fma_f32 v11, v11, v7, v8
  v_fma_f32 v12, v12, v7, v8
  v_fma_f32 v13, v13, v7, v8
  v_cvt_pk_bf16_f32 v170, v10, v11
  v_cvt_pk_bf16_f32 v171, v12, v13
  ds_read_b64_tr_b16 v[28:29], v4 offset:33792
  ds_read_b64_tr_b16 v[30:31], v4 offset:34048
  s_waitcnt lgkmcnt(10)
  v_mfma_f32_32x32x16_bf16 v[80:95], v[48:51], v[168:171], v[80:95]
  s_barrier
  ds_read_b64_tr_b16 v[48:49], v2 offset:36864
  ds_read_b64_tr_b16 v[50:51], v2 offset:37376
  v_lshlrev_b32 v10, 16, v172
  v_and_b32 v11, s67, v172
  v_lshlrev_b32 v12, 16, v173
  v_and_b32 v13, s67, v173
  v_fma_f32 v10, v10, v7, v8
  v_fma_f32 v11, v11, v7, v8
  v_fma_f32 v12, v12, v7, v8
  s_waitcnt lgkmcnt(10)
  v_mfma_f32_32x32x16_bf16 v[96:111], v[52:55], v[168:171], v[96:111]
  ds_read_b64_tr_b16 v[52:53], v3 offset:36864
  ds_read_b64_tr_b16 v[54:55], v3 offset:37376
  v_fma_f32 v13, v13, v7, v8
  v_cvt_pk_bf16_f32 v172, v10, v11
  v_cvt_pk_bf16_f32 v173, v12, v13
  v_lshlrev_b32 v10, 16, v174
  v_and_b32 v11, s67, v174
  v_lshlrev_b32 v12, 16, v175
  v_and_b32 v13, s67, v175
  s_waitcnt lgkmcnt(10)
  v_mfma_f32_32x32x16_bf16 v[112:127], v[168:171], v[56:59], v[112:127]
  v_fma_f32 v10, v10, v7, v8
  v_fma_f32 v11, v11, v7, v8
  v_fma_f32 v12, v12, v7, v8
  v_fma_f32 v13, v13, v7, v8
  v_cvt_pk_bf16_f32 v174, v10, v11
  v_cvt_pk_bf16_f32 v175, v12, v13
  ds_read_b64_tr_b16 v[56:57], v4 offset:36864
  ds_read_b64_tr_b16 v[58:59], v4 offset:37120
  s_waitcnt lgkmcnt(10)
  v_mfma_f32_32x32x16_bf16 v[80:95], v[60:63], v[172:175], v[80:95]
  ds_read_b64_tr_b16 v[60:61], v2 offset:39936
  ds_read_b64_tr_b16 v[62:63], v2 offset:40448
  v_lshlrev_b32 v10, 16, v176
  v_and_b32 v11, s67, v176
  v_lshlrev_b32 v12, 16, v177
  v_and_b32 v13, s67, v177
  v_fma_f32 v10, v10, v7, v8
  v_fma_f32 v11, v11, v7, v8
  v_fma_f32 v12, v12, v7, v8
  s_waitcnt lgkmcnt(10)
  v_mfma_f32_32x32x16_bf16 v[96:111], v[24:27], v[172:175], v[96:111]
  ds_read_b64_tr_b16 v[16:17], v3 offset:39936
  ds_read_b64_tr_b16 v[18:19], v3 offset:40448
  v_fma_f32 v13, v13, v7, v8
  v_cvt_pk_bf16_f32 v176, v10, v11
  v_cvt_pk_bf16_f32 v177, v12, v13
  v_lshlrev_b32 v10, 16, v178
  v_and_b32 v11, s67, v178
  v_lshlrev_b32 v12, 16, v179
  v_and_b32 v13, s67, v179
  s_waitcnt lgkmcnt(10)
  v_mfma_f32_32x32x16_bf16 v[112:127], v[172:175], v[28:31], v[112:127]
  v_fma_f32 v10, v10, v7, v8
  v_fma_f32 v11, v11, v7, v8
  v_fma_f32 v12, v12, v7, v8
  v_fma_f32 v13, v13, v7, v8
  v_cvt_pk_bf16_f32 v178, v10, v11
  v_cvt_pk_bf16_f32 v179, v12, v13
  ds_read_b64_tr_b16 v[20:21], v4 offset:39936
  ds_read_b64_tr_b16 v[22:23], v4 offset:40192
  s_waitcnt lgkmcnt(10)
  v_mfma_f32_32x32x16_bf16 v[80:95], v[48:51], v[176:179], v[80:95]
  ds_read_b64_tr_b16 v[48:49], v2 offset:43008
  ds_read_b64_tr_b16 v[50:51], v2 offset:43520
  v_lshlrev_b32 v10, 16, v180
  v_and_b32 v11, s67, v180
  v_lshlrev_b32 v12, 16, v181
  v_and_b32 v13, s67, v181
  v_fma_f32 v10, v10, v7, v8
  v_fma_f32 v11, v11, v7, v8
  v_fma_f32 v12, v12, v7, v8
  s_waitcnt lgkmcnt(10)
  v_mfma_f32_32x32x16_bf16 v[96:111], v[52:55], v[176:179], v[96:111]
  ds_read_b64_tr_b16 v[52:53], v3 offset:43008
  ds_read_b64_tr_b16 v[54:55], v3 offset:43520
  v_fma_f32 v13, v13, v7, v8
  v_cvt_pk_bf16_f32 v180, v10, v11
  v_cvt_pk_bf16_f32 v181, v12, v13
  v_lshlrev_b32 v10, 16, v182
  v_and_b32 v11, s67, v182
  v_lshlrev_b32 v12, 16, v183
  v_and_b32 v13, s67, v183
  s_waitcnt lgkmcnt(10)
  v_mfma_f32_32x32x16_bf16 v[112:127], v[176:179], v[56:59], v[112:127]
  v_fma_f32 v10, v10, v7, v8
  v_fma_f32 v11, v11, v7, v8
  v_fma_f32 v12, v12, v7, v8
  v_fma_f32 v13, v13, v7, v8
  v_cvt_pk_bf16_f32 v182, v10, v11
  v_cvt_pk_bf16_f32 v183, v12, v13
  ds_read_b64_tr_b16 v[56:57], v4 offset:43008
  ds_read_b64_tr_b16 v[58:59], v4 offset:43264
  s_waitcnt lgkmcnt(10)
  v_mfma_f32_32x32x16_bf16 v[80:95], v[60:63], v[180:183], v[80:95]
  ds_read_b64_tr_b16 v[60:61], v2 offset:46080
  ds_read_b64_tr_b16 v[62:63], v2 offset:46592
  v_lshlrev_b32 v10, 16, v184
  v_and_b32 v11, s67, v184
  v_lshlrev_b32 v12, 16, v185
  v_and_b32 v13, s67, v185
  v_fma_f32 v10, v10, v7, v8
  v_fma_f32 v11, v11, v7, v8
  v_fma_f32 v12, v12, v7, v8
  s_waitcnt lgkmcnt(10)
  v_mfma_f32_32x32x16_bf16 v[96:111], v[16:19], v[180:183], v[96:111]
  ds_read_b64_tr_b16 v[24:25], v3 offset:46080
  ds_read_b64_tr_b16 v[26:27], v3 offset:46592
  v_fma_f32 v13, v13, v7, v8
  v_cvt_pk_bf16_f32 v184, v10, v11
  v_cvt_pk_bf16_f32 v185, v12, v13
  v_lshlrev_b32 v10, 16, v186
  v_and_b32 v11, s67, v186
  v_lshlrev_b32 v12, 16, v187
  v_and_b32 v13, s67, v187
  s_waitcnt lgkmcnt(10)
  v_mfma_f32_32x32x16_bf16 v[112:127], v[180:183], v[20:23], v[112:127]
  v_fma_f32 v10, v10, v7, v8
  v_fma_f32 v11, v11, v7, v8
  v_fma_f32 v12, v12, v7, v8
  v_fma_f32 v13, v13, v7, v8
  v_cvt_pk_bf16_f32 v186, v10, v11
  v_cvt_pk_bf16_f32 v187, v12, v13
  ds_read_b64_tr_b16 v[28:29], v4 offset:46080
  ds_read_b64_tr_b16 v[30:31], v4 offset:46336
  s_waitcnt lgkmcnt(10)
  v_mfma_f32_32x32x16_bf16 v[80:95], v[48:51], v[184:187], v[80:95]
  s_barrier
  v_add_u32 v2, 49152, v2
  v_add_u32 v3, 49152, v3
  v_add_u32 v4, 49152, v4
  ds_read_b64_tr_b16 v[48:49], v2 offset:0
  ds_read_b64_tr_b16 v[50:51], v2 offset:512
  v_lshlrev_b32 v10, 16, v188
  v_and_b32 v11, s67, v188
  v_lshlrev_b32 v12, 16, v189
  v_and_b32 v13, s67, v189
  v_fma_f32 v10, v10, v7, v8
  v_fma_f32 v11, v11, v7, v8
  v_fma_f32 v12, v12, v7, v8
  s_waitcnt lgkmcnt(10)
  v_mfma_f32_32x32x16_bf16 v[96:111], v[52:55], v[184:187], v[96:111]
  ds_read_b64_tr_b16 v[52:53], v3 offset:0
  ds_read_b64_tr_b16 v[54:55], v3 offset:512
  v_fma_f32 v13, v13, v7, v8
  v_cvt_pk_bf16_f32 v188, v10, v11
  v_cvt_pk_bf16_f32 v189, v12, v13
  v_lshlrev_b32 v10, 16, v190
  v_and_b32 v11, s67, v190
  v_lshlrev_b32 v12, 16, v191
  v_and_b32 v13, s67, v191
  s_waitcnt lgkmcnt(10)
  v_mfma_f32_32x32x16_bf16 v[112:127], v[184:187], v[56:59], v[112:127]
  v_fma_f32 v10, v10, v7, v8
  v_fma_f32 v11, v11, v7, v8
  v_fma_f32 v12, v12, v7, v8
  v_fma_f32 v13, v13, v7, v8
  v_cvt_pk_bf16_f32 v190, v10, v11
  v_cvt_pk_bf16_f32 v191, v12, v13
  ds_read_b64_tr_b16 v[56:57], v4 offset:0
  ds_read_b64_tr_b16 v[58:59], v4 offset:256
  s_waitcnt lgkmcnt(10)
  v_mfma_f32_32x32x16_bf16 v[80:95], v[60:63], v[188:191], v[80:95]
  ds_read_b64_tr_b16 v[60:61], v2 offset:3072
  ds_read_b64_tr_b16 v[62:63], v2 offset:3584
  v_lshlrev_b32 v10, 16, v192
  v_and_b32 v11, s67, v192
  v_lshlrev_b32 v12, 16, v193
  v_and_b32 v13, s67, v193
  v_fma_f32 v10, v10, v7, v8
  v_fma_f32 v11, v11, v7, v8
  v_fma_f32 v12, v12, v7, v8
  s_waitcnt lgkmcnt(10)
  v_mfma_f32_32x32x16_bf16 v[96:111], v[24:27], v[188:191], v[96:111]
  ds_read_b64_tr_b16 v[16:17], v3 offset:3072
  ds_read_b64_tr_b16 v[18:19], v3 offset:3584
  v_fma_f32 v13, v13, v7, v8
  v_cvt_pk_bf16_f32 v192, v10, v11
  v_cvt_pk_bf16_f32 v193, v12, v13
  v_lshlrev_b32 v10, 16, v194
  v_and_b32 v11, s67, v194
  v_lshlrev_b32 v12, 16, v195
  v_and_b32 v13, s67, v195
  s_waitcnt lgkmcnt(10)
  v_mfma_f32_32x32x16_bf16 v[112:127], v[188:191], v[28:31], v[112:127]
  v_fma_f32 v10, v10, v7, v8
  v_fma_f32 v11, v11, v7, v8
  v_fma_f32 v12, v12, v7, v8
  v_fma_f32 v13, v13, v7, v8
  v_cvt_pk_bf16_f32 v194, v10, v11
  v_cvt_pk_bf16_f32 v195, v12, v13
  ds_read_b64_tr_b16 v[20:21], v4 offset:3072
  ds_read_b64_tr_b16 v[22:23], v4 offset:3328
  s_waitcnt lgkmcnt(10)
  v_mfma_f32_32x32x16_bf16 v[80:95], v[48:51], v[192:195], v[80:95]
  ds_read_b64_tr_b16 v[48:49], v2 offset:6144
  ds_read_b64_tr_b16 v[50:51], v2 offset:6656
  v_lshlrev_b32 v10, 16, v196
  v_and_b32 v11, s67, v196
  v_lshlrev_b32 v12, 16, v197
  v_and_b32 v13, s67, v197
  v_fma_f32 v10, v10, v7, v8
  v_fma_f32 v11, v11, v7, v8
  v_fma_f32 v12, v12, v7, v8
  s_waitcnt lgkmcnt(10)
  v_mfma_f32_32x32x16_bf16 v[96:111], v[52:55], v[192:195], v[96:111]
  ds_read_b64_tr_b16 v[52:53], v3 offset:6144
  ds_read_b64_tr_b16 v[54:55], v3 offset:6656
  v_fma_f32 v13, v13, v7, v8
  v_cvt_pk_bf16_f32 v196, v10, v11
  v_cvt_pk_bf16_f32 v197, v12, v13
  v_lshlrev_b32 v10, 16, v198
  v_and_b32 v11, s67, v198
  v_lshlrev_b32 v12, 16, v199
  v_and_b32 v13, s67, v199
  s_waitcnt lgkmcnt(10)
  v_mfma_f32_32x32x16_bf16 v[112:127], v[192:195], v[56:59], v[112:127]
  v_fma_f32 v10, v10, v7, v8
  v_fma_f32 v11, v11, v7, v8
  v_fma_f32 v12, v12, v7, v8
  v_fma_f32 v13, v13, v7, v8
  v_cvt_pk_bf16_f32 v198, v10, v11
  v_cvt_pk_bf16_f32 v199, v12, v13
  ds_read_b64_tr_b16 v[56:57], v4 offset:6144
  ds_read_b64_tr_b16 v[58:59], v4 offset:6400
  s_waitcnt lgkmcnt(10)
  v_mfma_f32_32x32x16_bf16 v[80:95], v[60:63], v[196:199], v[80:95]
  ds_read_b64_tr_b16 v[60:61], v2 offset:9216
  ds_read_b64_tr_b16 v[62:63], v2 offset:9728
  v_lshlrev_b32 v10, 16, v200
  v_and_b32 v11, s67, v200
  v_lshlrev_b32 v12, 16, v201
  v_and_b32 v13, s67, v201
  v_fma_f32 v10, v10, v7, v8
  v_fma_f32 v11, v11, v7, v8
  v_fma_f32 v12, v12, v7, v8
  s_waitcnt lgkmcnt(10)
  v_mfma_f32_32x32x16_bf16 v[96:111], v[16:19], v[196:199], v[96:111]
  ds_read_b64_tr_b16 v[24:25], v3 offset:9216
  ds_read_b64_tr_b16 v[26:27], v3 offset:9728
  v_fma_f32 v13, v13, v7, v8
  v_cvt_pk_bf16_f32 v200, v10, v11
  v_cvt_pk_bf16_f32 v201, v12, v13
  v_lshlrev_b32 v10, 16, v202
  v_and_b32 v11, s67, v202
  v_lshlrev_b32 v12, 16, v203
  v_and_b32 v13, s67, v203
  s_waitcnt lgkmcnt(10)
  v_mfma_f32_32x32x16_bf16 v[112:127], v[196:199], v[20:23], v[112:127]
  v_fma_f32 v10, v10, v7, v8
  v_fma_f32 v11, v11, v7, v8
  v_fma_f32 v12, v12, v7, v8
  v_fma_f32 v13, v13, v7, v8
  v_cvt_pk_bf16_f32 v202, v10, v11
  v_cvt_pk_bf16_f32 v203, v12, v13
  ds_read_b64_tr_b16 v[28:29], v4 offset:9216
  ds_read_b64_tr_b16 v[30:31], v4 offset:9472
  s_waitcnt lgkmcnt(10)
  v_mfma_f32_32x32x16_bf16 v[80:95], v[48:51], v[200:203], v[80:95]
  s_barrier
  ds_read_b64_tr_b16 v[48:49], v2 offset:12288
  ds_read_b64_tr_b16 v[50:51], v2 offset:12800
  v_lshlrev_b32 v10, 16, v204
  v_and_b32 v11, s67, v204
  v_lshlrev_b32 v12, 16, v205
  v_and_b32 v13, s67, v205
  v_fma_f32 v10, v10, v7, v8
  v_fma_f32 v11, v11, v7, v8
  v_fma_f32 v12, v12, v7, v8
  s_waitcnt lgkmcnt(10)
  v_mfma_f32_32x32x16_bf16 v[96:111], v[52:55], v[200:203], v[96:111]
  ds_read_b64_tr_b16 v[52:53], v3 offset:12288
  ds_read_b64_tr_b16 v[54:55], v3 offset:12800
  v_fma_f32 v13, v13, v7, v8
  v_cvt_pk_bf16_f32 v204, v10, v11
  v_cvt_pk_bf16_f32 v205, v12, v13
  v_lshlrev_b32 v10, 16, v206
  v_and_b32 v11, s67, v206
  v_lshlrev_b32 v12, 16, v207
  v_and_b32 v13, s67, v207
  s_waitcnt lgkmcnt(10)
  v_mfma_f32_32x32x16_bf16 v[112:127], v[200:203], v[56:59], v[112:127]
  v_fma_f32 v10, v10, v7, v8
  v_fma_f32 v11, v11, v7, v8
  v_fma_f32 v12, v12, v7, v8
  v_fma_f32 v13, v13, v7, v8
  v_cvt_pk_bf16_f32 v206, v10, v11
  v_cvt_pk_bf16_f32 v207, v12, v13
  ds_read_b64_tr_b16 v[56:57], v4 offset:12288
  ds_read_b64_tr_b16 v[58:59], v4 offset:12544
  s_waitcnt lgkmcnt(10)
  v_mfma_f32_32x32x16_bf16 v[80:95], v[60:63], v[204:207], v[80:95]
  ds_read_b64_tr_b16 v[60:61], v2 offset:15360
  ds_read_b64_tr_b16 v[62:63], v2 offset:15872
  v_lshlrev_b32 v10, 16, v208
  v_and_b32 v11, s67, v208
  v_lshlrev_b32 v12, 16, v209
  v_and_b32 v13, s67, v209
  v_fma_f32 v10, v10, v7, v8
  v_fma_f32 v11, v11, v7, v8
  v_fma_f32 v12, v12, v7, v8
  s_waitcnt lgkmcnt(10)
  v_mfma_f32_32x32x16_bf16 v[96:111], v[24:27], v[204:207], v[96:111]
  ds_read_b64_tr_b16 v[16:17], v3 offset:15360
  ds_read_b64_tr_b16 v[18:19], v3 offset:15872
  v_fma_f32 v13, v13, v7, v8
  v_cvt_pk_bf16_f32 v208, v10, v11
  v_cvt_pk_bf16_f32 v209, v12, v13
  v_lshlrev_b32 v10, 16, v210
  v_and_b32 v11, s67, v210
  v_lshlrev_b32 v12, 16, v211
  v_and_b32 v13, s67, v211
  s_waitcnt lgkmcnt(10)
  v_mfma_f32_32x32x16_bf16 v[112:127], v[204:207], v[28:31], v[112:127]
  v_fma_f32 v10, v10, v7, v8
  v_fma_f32 v11, v11, v7, v8
  v_fma_f32 v12, v12, v7, v8
  v_fma_f32 v13, v13, v7, v8
  v_cvt_pk_bf16_f32 v210, v10, v11
  v_cvt_pk_bf16_f32 v211, v12, v13
  ds_read_b64_tr_b16 v[20:21], v4 offset:15360
  ds_read_b64_tr_b16 v[22:23], v4 offset:15616
  s_waitcnt lgkmcnt(10)
  v_mfma_f32_32x32x16_bf16 v[80:95], v[48:51], v[208:211], v[80:95]
  ds_read_b64_tr_b16 v[48:49], v2 offset:18432
  ds_read_b64_tr_b16 v[50:51], v2 offset:18944
  v_lshlrev_b32 v10, 16, v212
  v_and_b32 v11, s67, v212
  v_lshlrev_b32 v12, 16, v213
  v_and_b32 v13, s67, v213
  v_fma_f32 v10, v10, v7, v8
  v_fma_f32 v11, v11, v7, v8
  v_fma_f32 v12, v12, v7, v8
  s_waitcnt lgkmcnt(10)
  v_mfma_f32_32x32x16_bf16 v[96:111], v[52:55], v[208:211], v[96:111]
  ds_read_b64_tr_b16 v[52:53], v3 offset:18432
  ds_read_b64_tr_b16 v[54:55], v3 offset:18944
  v_fma_f32 v13, v13, v7, v8
  v_cvt_pk_bf16_f32 v212, v10, v11
  v_cvt_pk_bf16_f32 v213, v12, v13
  v_lshlrev_b32 v10, 16, v214
  v_and_b32 v11, s67, v214
  v_lshlrev_b32 v12, 16, v215
  v_and_b32 v13, s67, v215
  s_waitcnt lgkmcnt(10)
  v_mfma_f32_32x32x16_bf16 v[112:127], v[208:211], v[56:59], v[112:127]
  v_fma_f32 v10, v10, v7, v8
  v_fma_f32 v11, v11, v7, v8
  v_fma_f32 v12, v12, v7, v8
  v_fma_f32 v13, v13, v7, v8
  v_cvt_pk_bf16_f32 v214, v10, v11
  v_cvt_pk_bf16_f32 v215, v12, v13
  ds_read_b64_tr_b16 v[56:57], v4 offset:18432
  ds_read_b64_tr_b16 v[58:59], v4 offset:18688
  s_waitcnt lgkmcnt(10)
  v_mfma_f32_32x32x16_bf16 v[80:95], v[60:63], v[212:215], v[80:95]
  ds_read_b64_tr_b16 v[60:61], v2 offset:21504
  ds_read_b64_tr_b16 v[62:63], v2 offset:22016
  v_lshlrev_b32 v10, 16, v216
  v_and_b32 v11, s67, v216
  v_lshlrev_b32 v12, 16, v217
  v_and_b32 v13, s67, v217
  v_fma_f32 v10, v10, v7, v8
  v_fma_f32 v11, v11, v7, v8
  v_fma_f32 v12, v12, v7, v8
  s_waitcnt lgkmcnt(10)
  v_mfma_f32_32x32x16_bf16 v[96:111], v[16:19], v[212:215], v[96:111]
  ds_read_b64_tr_b16 v[24:25], v3 offset:21504
  ds_read_b64_tr_b16 v[26:27], v3 offset:22016
  v_fma_f32 v13, v13, v7, v8
  v_cvt_pk_bf16_f32 v216, v10, v11
  v_cvt_pk_bf16_f32 v217, v12, v13
  v_lshlrev_b32 v10, 16, v218
  v_and_b32 v11, s67, v218
  v_lshlrev_b32 v12, 16, v219
  v_and_b32 v13, s67, v219
  s_waitcnt lgkmcnt(10)
  v_mfma_f32_32x32x16_bf16 v[112:127], v[212:215], v[20:23], v[112:127]
  v_fma_f32 v10, v10, v7, v8
  v_fma_f32 v11, v11, v7, v8
  v_fma_f32 v12, v12, v7, v8
  v_fma_f32 v13, v13, v7, v8
  v_cvt_pk_bf16_f32 v218, v10, v11
  v_cvt_pk_bf16_f32 v219, v12, v13
  ds_read_b64_tr_b16 v[28:29], v4 offset:21504
  ds_read_b64_tr_b16 v[30:31], v4 offset:21760
  s_waitcnt lgkmcnt(10)
  v_mfma_f32_32x32x16_bf16 v[80:95], v[48:51], v[216:219], v[80:95]
  s_barrier
  ds_read_b64_tr_b16 v[48:49], v2 offset:24576
  ds_read_b64_tr_b16 v[50:51], v2 offset:25088
  v_lshlrev_b32 v10, 16, v220
  v_and_b32 v11, s67, v220
  v_lshlrev_b32 v12, 16, v221
  v_and_b32 v13, s67, v221
  v_fma_f32 v10, v10, v7, v8
  v_fma_f32 v11, v11, v7, v8
  v_fma_f32 v12, v12, v7, v8
  s_waitcnt lgkmcnt(10)
  v_mfma_f32_32x32x16_bf16 v[96:111], v[52:55], v[216:219], v[96:111]
  ds_read_b64_tr_b16 v[52:53], v3 offset:24576
  ds_read_b64_tr_b16 v[54:55], v3 offset:25088
  v_fma_f32 v13, v13, v7, v8
  v_cvt_pk_bf16_f32 v220, v10, v11
  v_cvt_pk_bf16_f32 v221, v12, v13
  v_lshlrev_b32 v10, 16, v222
  v_and_b32 v11, s67, v222
  v_lshlrev_b32 v12, 16, v223
  v_and_b32 v13, s67, v223
  s_waitcnt lgkmcnt(10)
  v_mfma_f32_32x32x16_bf16 v[112:127], v[216:219], v[56:59], v[112:127]
  v_fma_f32 v10, v10, v7, v8
  v_fma_f32 v11, v11, v7, v8
  v_fma_f32 v12, v12, v7, v8
  v_fma_f32 v13, v13, v7, v8
  v_cvt_pk_bf16_f32 v222, v10, v11
  v_cvt_pk_bf16_f32 v223, v12, v13
  ds_read_b64_tr_b16 v[56:57], v4 offset:24576
  ds_read_b64_tr_b16 v[58:59], v4 offset:24832
  s_waitcnt lgkmcnt(10)
  v_mfma_f32_32x32x16_bf16 v[80:95], v[60:63], v[220:223], v[80:95]
  ds_read_b64_tr_b16 v[60:61], v2 offset:27648
  ds_read_b64_tr_b16 v[62:63], v2 offset:28160
  v_lshlrev_b32 v10, 16, v224
  v_and_b32 v11, s67, v224
  v_lshlrev_b32 v12, 16, v225
  v_and_b32 v13, s67, v225
  v_fma_f32 v10, v10, v7, v8
  v_fma_f32 v11, v11, v7, v8
  v_fma_f32 v12, v12, v7, v8
  s_waitcnt lgkmcnt(10)
  v_mfma_f32_32x32x16_bf16 v[96:111], v[24:27], v[220:223], v[96:111]
  ds_read_b64_tr_b16 v[16:17], v3 offset:27648
  ds_read_b64_tr_b16 v[18:19], v3 offset:28160
  v_fma_f32 v13, v13, v7, v8
  v_cvt_pk_bf16_f32 v224, v10, v11
  v_cvt_pk_bf16_f32 v225, v12, v13
  v_lshlrev_b32 v10, 16, v226
  v_and_b32 v11, s67, v226
  v_lshlrev_b32 v12, 16, v227
  v_and_b32 v13, s67, v227
  s_waitcnt lgkmcnt(10)
  v_mfma_f32_32x32x16_bf16 v[112:127], v[220:223], v[28:31], v[112:127]
  v_fma_f32 v10, v10, v7, v8
  v_fma_f32 v11, v11, v7, v8
  v_fma_f32 v12, v12, v7, v8
  v_fma_f32 v13, v13, v7, v8
  v_cvt_pk_bf16_f32 v226, v10, v11
  v_cvt_pk_bf16_f32 v227, v12, v13
  ds_read_b64_tr_b16 v[20:21], v4 offset:27648
  ds_read_b64_tr_b16 v[22:23], v4 offset:27904
  s_waitcnt lgkmcnt(10)
  v_mfma_f32_32x32x16_bf16 v[80:95], v[48:51], v[224:227], v[80:95]
  ds_read_b64_tr_b16 v[48:49], v2 offset:30720
  ds_read_b64_tr_b16 v[50:51], v2 offset:31232
  v_lshlrev_b32 v10, 16, v228
  v_and_b32 v11, s67, v228
  v_lshlrev_b32 v12, 16, v229
  v_and_b32 v13, s67, v229
  v_fma_f32 v10, v10, v7, v8
  v_fma_f32 v11, v11, v7, v8
  v_fma_f32 v12, v12, v7, v8
  s_waitcnt lgkmcnt(10)
  v_mfma_f32_32x32x16_bf16 v[96:111], v[52:55], v[224:227], v[96:111]
  ds_read_b64_tr_b16 v[52:53], v3 offset:30720
  ds_read_b64_tr_b16 v[54:55], v3 offset:31232
  v_fma_f32 v13, v13, v7, v8
  v_cvt_pk_bf16_f32 v228, v10, v11
  v_cvt_pk_bf16_f32 v229, v12, v13
  v_lshlrev_b32 v10, 16, v230
  v_and_b32 v11, s67, v230
  v_lshlrev_b32 v12, 16, v231
  v_and_b32 v13, s67, v231
  s_waitcnt lgkmcnt(10)
  v_mfma_f32_32x32x16_bf16 v[112:127], v[224:227], v[56:59], v[112:127]
  v_fma_f32 v10, v10, v7, v8
  v_fma_f32 v11, v11, v7, v8
  v_fma_f32 v12, v12, v7, v8
  v_fma_f32 v13, v13, v7, v8
  v_cvt_pk_bf16_f32 v230, v10, v11
  v_cvt_pk_bf16_f32 v231, v12, v13
  ds_read_b64_tr_b16 v[56:57], v4 offset:30720
  ds_read_b64_tr_b16 v[58:59], v4 offset:30976
  s_waitcnt lgkmcnt(10)
  v_mfma_f32_32x32x16_bf16 v[80:95], v[60:63], v[228:231], v[80:95]
  ds_read_b64_tr_b16 v[60:61], v2 offset:33792
  ds_read_b64_tr_b16 v[62:63], v2 offset:34304
  v_lshlrev_b32 v10, 16, v232
  v_and_b32 v11, s67, v232
  v_lshlrev_b32 v12, 16, v233
  v_and_b32 v13, s67, v233
  v_fma_f32 v10, v10, v7, v8
  v_fma_f32 v11, v11, v7, v8
  v_fma_f32 v12, v12, v7, v8
  s_waitcnt lgkmcnt(10)
  v_mfma_f32_32x32x16_bf16 v[96:111], v[16:19], v[228:231], v[96:111]
  ds_read_b64_tr_b16 v[24:25], v3 offset:33792
  ds_read_b64_tr_b16 v[26:27], v3 offset:34304
  v_fma_f32 v13, v13, v7, v8
  v_cvt_pk_bf16_f32 v232, v10, v11
  v_cvt_pk_bf16_f32 v233, v12, v13
  v_lshlrev_b32 v10, 16, v234
  v_and_b32 v11, s67, v234
  v_lshlrev_b32 v12, 16, v235
  v_and_b32 v13, s67, v235
  s_waitcnt lgkmcnt(10)
  v_mfma_f32_32x32x16_bf16 v[112:127], v[228:231], v[20:23], v[112:127]
  v_fma_f32 v10, v10, v7, v8
  v_fma_f32 v11, v11, v7, v8
  v_fma_f32 v12, v12, v7, v8
  v_fma_f32 v13, v13, v7, v8
  v_cvt_pk_bf16_f32 v234, v10, v11
  v_cvt_pk_bf16_f32 v235, v12, v13
  ds_read_b64_tr_b16 v[28:29], v4 offset:33792
  ds_read_b64_tr_b16 v[30:31], v4 offset:34048
  s_waitcnt lgkmcnt(10)
  v_mfma_f32_32x32x16_bf16 v[80:95], v[48:51], v[232:235], v[80:95]
  s_barrier
  ds_read_b64_tr_b16 v[48:49], v2 offset:36864
  ds_read_b64_tr_b16 v[50:51], v2 offset:37376
  v_lshlrev_b32 v10, 16, v236
  v_and_b32 v11, s67, v236
  v_lshlrev_b32 v12, 16, v237
  v_and_b32 v13, s67, v237
  v_fma_f32 v10, v10, v7, v8
  v_fma_f32 v11, v11, v7, v8
  v_fma_f32 v12, v12, v7, v8
  s_waitcnt lgkmcnt(10)
  v_mfma_f32_32x32x16_bf16 v[96:111], v[52:55], v[232:235], v[96:111]
  ds_read_b64_tr_b16 v[52:53], v3 offset:36864
  ds_read_b64_tr_b16 v[54:55], v3 offset:37376
  v_fma_f32 v13, v13, v7, v8
  v_cvt_pk_bf16_f32 v236, v10, v11
  v_cvt_pk_bf16_f32 v237, v12, v13
  v_lshlrev_b32 v10, 16, v238
  v_and_b32 v11, s67, v238
  v_lshlrev_b32 v12, 16, v239
  v_and_b32 v13, s67, v239
  s_waitcnt lgkmcnt(10)
  v_mfma_f32_32x32x16_bf16 v[112:127], v[232:235], v[56:59], v[112:127]
  v_fma_f32 v10, v10, v7, v8
  v_fma_f32 v11, v11, v7, v8
  v_fma_f32 v12, v12, v7, v8
  v_fma_f32 v13, v13, v7, v8
  v_cvt_pk_bf16_f32 v238, v10, v11
  v_cvt_pk_bf16_f32 v239, v12, v13
  ds_read_b64_tr_b16 v[56:57], v4 offset:36864
  ds_read_b64_tr_b16 v[58:59], v4 offset:37120
  s_waitcnt lgkmcnt(10)
  v_mfma_f32_32x32x16_bf16 v[80:95], v[60:63], v[236:239], v[80:95]
  ds_read_b64_tr_b16 v[60:61], v2 offset:39936
  ds_read_b64_tr_b16 v[62:63], v2 offset:40448
  v_lshlrev_b32 v10, 16, v240
  v_and_b32 v11, s67, v240
  v_lshlrev_b32 v12, 16, v241
  v_and_b32 v13, s67, v241
  v_fma_f32 v10, v10, v7, v8
  v_fma_f32 v11, v11, v7, v8
  v_fma_f32 v12, v12, v7, v8
  s_waitcnt lgkmcnt(10)
  v_mfma_f32_32x32x16_bf16 v[96:111], v[24:27], v[236:239], v[96:111]
  ds_read_b64_tr_b16 v[16:17], v3 offset:39936
  ds_read_b64_tr_b16 v[18:19], v3 offset:40448
  v_fma_f32 v13, v13, v7, v8
  v_cvt_pk_bf16_f32 v240, v10, v11
  v_cvt_pk_bf16_f32 v241, v12, v13
  v_lshlrev_b32 v10, 16, v242
  v_and_b32 v11, s67, v242
  v_lshlrev_b32 v12, 16, v243
  v_and_b32 v13, s67, v243
  s_waitcnt lgkmcnt(10)
  v_mfma_f32_32x32x16_bf16 v[112:127], v[236:239], v[28:31], v[112:127]
  v_fma_f32 v10, v10, v7, v8
  v_fma_f32 v11, v11, v7, v8
  v_fma_f32 v12, v12, v7, v8
  v_fma_f32 v13, v13, v7, v8
  v_cvt_pk_bf16_f32 v242, v10, v11
  v_cvt_pk_bf16_f32 v243, v12, v13
  ds_read_b64_tr_b16 v[20:21], v4 offset:39936
  ds_read_b64_tr_b16 v[22:23], v4 offset:40192
  s_waitcnt lgkmcnt(10)
  v_mfma_f32_32x32x16_bf16 v[80:95], v[48:51], v[240:243], v[80:95]
  ds_read_b64_tr_b16 v[48:49], v2 offset:43008
  ds_read_b64_tr_b16 v[50:51], v2 offset:43520
  v_lshlrev_b32 v10, 16, v244
  v_and_b32 v11, s67, v244
  v_lshlrev_b32 v12, 16, v245
  v_and_b32 v13, s67, v245
  v_fma_f32 v10, v10, v7, v8
  v_fma_f32 v11, v11, v7, v8
  v_fma_f32 v12, v12, v7, v8
  s_waitcnt lgkmcnt(10)
  v_mfma_f32_32x32x16_bf16 v[96:111], v[52:55], v[240:243], v[96:111]
  ds_read_b64_tr_b16 v[52:53], v3 offset:43008
  ds_read_b64_tr_b16 v[54:55], v3 offset:43520
  v_fma_f32 v13, v13, v7, v8
  v_cvt_pk_bf16_f32 v244, v10, v11
  v_cvt_pk_bf16_f32 v245, v12, v13
  v_lshlrev_b32 v10, 16, v246
  v_and_b32 v11, s67, v246
  v_lshlrev_b32 v12, 16, v247
  v_and_b32 v13, s67, v247
  s_waitcnt lgkmcnt(10)
  v_mfma_f32_32x32x16_bf16 v[112:127], v[240:243], v[56:59], v[112:127]
  v_fma_f32 v10, v10, v7, v8
  v_fma_f32 v11, v11, v7, v8
  v_fma_f32 v12, v12, v7, v8
  v_fma_f32 v13, v13, v7, v8
  v_cvt_pk_bf16_f32 v246, v10, v11
  v_cvt_pk_bf16_f32 v247, v12, v13
  ds_read_b64_tr_b16 v[56:57], v4 offset:43008
  ds_read_b64_tr_b16 v[58:59], v4 offset:43264
  s_waitcnt lgkmcnt(10)
  v_mfma_f32_32x32x16_bf16 v[80:95], v[60:63], v[244:247], v[80:95]
  ds_read_b64_tr_b16 v[60:61], v2 offset:46080
  ds_read_b64_tr_b16 v[62:63], v2 offset:46592
  v_lshlrev_b32 v10, 16, v248
  v_and_b32 v11, s67, v248
  v_lshlrev_b32 v12, 16, v249
  v_and_b32 v13, s67, v249
  v_fma_f32 v10, v10, v7, v8
  v_fma_f32 v11, v11, v7, v8
  v_fma_f32 v12, v12, v7, v8
  s_waitcnt lgkmcnt(10)
  v_mfma_f32_32x32x16_bf16 v[96:111], v[16:19], v[244:247], v[96:111]
  ds_read_b64_tr_b16 v[24:25], v3 offset:46080
  ds_read_b64_tr_b16 v[26:27], v3 offset:46592
  v_fma_f32 v13, v13, v7, v8
  v_cvt_pk_bf16_f32 v248, v10, v11
  v_cvt_pk_bf16_f32 v249, v12, v13
  v_lshlrev_b32 v10, 16, v250
  v_and_b32 v11, s67, v250
  v_lshlrev_b32 v12, 16, v251
  v_and_b32 v13, s67, v251
  s_waitcnt lgkmcnt(10)
  v_mfma_f32_32x32x16_bf16 v[112:127], v[244:247], v[20:23], v[112:127]
  v_fma_f32 v10, v10, v7, v8
  v_fma_f32 v11, v11, v7, v8
  v_fma_f32 v12, v12, v7, v8
  v_fma_f32 v13, v13, v7, v8
  v_cvt_pk_bf16_f32 v250, v10, v11
  v_cvt_pk_bf16_f32 v251, v12, v13
  ds_read_b64_tr_b16 v[28:29], v4 offset:46080
  ds_read_b64_tr_b16 v[30:31], v4 offset:46336
  s_waitcnt lgkmcnt(10)
  v_mfma_f32_32x32x16_bf16 v[80:95], v[48:51], v[248:251], v[80:95]
  s_barrier
  ds_read_b64_tr_b16 v[48:49], v5 offset:0
  ds_read_b64_tr_b16 v[50:51], v5 offset:768
  v_lshlrev_b32 v10, 16, v252
  v_and_b32 v11, s67, v252
  v_lshlrev_b32 v12, 16, v253
  v_and_b32 v13, s67, v253
  v_fma_f32 v10, v10, v7, v8
  v_fma_f32 v11, v11, v7, v8
  v_fma_f32 v12, v12, v7, v8
  s_waitcnt lgkmcnt(10)
  v_mfma_f32_32x32x16_bf16 v[96:111], v[52:55], v[248:251], v[96:111]
  ds_read_b64_tr_b16 v[16:17], v6 offset:0
  ds_read_b64_tr_b16 v[18:19], v6 offset:768
  v_fma_f32 v13, v13, v7, v8
  v_cvt_pk_bf16_f32 v252, v10, v11
  v_cvt_pk_bf16_f32 v253, v12, v13
  v_lshlrev_b32 v10, 16, v254
  v_and_b32 v11, s67, v254
  v_lshlrev_b32 v12, 16, v255
  v_and_b32 v13, s67, v255
  s_waitcnt lgkmcnt(10)
  v_mfma_f32_32x32x16_bf16 v[112:127], v[248:251], v[56:59], v[112:127]
  v_fma_f32 v10, v10, v7, v8
  v_fma_f32 v11, v11, v7, v8
  v_fma_f32 v12, v12, v7, v8
  v_fma_f32 v13, v13, v7, v8
  v_cvt_pk_bf16_f32 v254, v10, v11
  v_cvt_pk_bf16_f32 v255, v12, v13
  ds_read_b64_tr_b16 v[20:21], v5 offset:64
  ds_read_b64_tr_b16 v[22:23], v5 offset:832
  s_waitcnt lgkmcnt(10)
  v_mfma_f32_32x32x16_bf16 v[80:95], v[60:63], v[252:255], v[80:95]
  s_waitcnt lgkmcnt(8)
  v_mfma_f32_32x32x16_bf16 v[96:111], v[24:27], v[252:255], v[96:111]
  ds_read_b64_tr_b16 v[24:25], v5 offset:6144
  ds_read_b64_tr_b16 v[26:27], v5 offset:6912
  s_waitcnt lgkmcnt(8)
  v_mfma_f32_32x32x16_bf16 v[112:127], v[252:255], v[28:31], v[112:127]
  ds_read_b64_tr_b16 v[28:29], v6 offset:6144
  ds_read_b64_tr_b16 v[30:31], v6 offset:6912
  s_waitcnt lgkmcnt(8)
  v_mfma_f32_32x32x16_bf16 v[32:47], v[48:51], v[128:131], 0
  s_nop 1
  v_mul_f32 v80, s72, v80
  v_mul_f32 v81, s72, v81
  v_mul_f32 v82, s72, v82
  v_mul_f32 v83, s72, v83
  v_mul_f32 v84, s72, v84
  s_waitcnt lgkmcnt(6)
  v_mfma_f32_32x32x16_bf16 v[48:63], v[16:19], v[128:131], 0
  ds_read_b64_tr_b16 v[16:17], v5 offset:6208
  ds_read_b64_tr_b16 v[18:19], v5 offset:6976
  v_mul_f32 v85, s72, v85
  v_mul_f32 v86, s72, v86
  v_mul_f32 v87, s72, v87
  v_mul_f32 v88, s72, v88
  v_mul_f32 v89, s72, v89
  s_waitcnt lgkmcnt(6)
  v_mfma_f32_32x32x16_bf16 v[64:79], v[20:23], v[128:131], 0
  ds_read_b64_tr_b16 v[20:21], v5 offset:12288
  ds_read_b64_tr_b16 v[22:23], v5 offset:13056
  v_mul_f32 v90, s72, v90
  v_mul_f32 v91, s72, v91
  v_mul_f32 v92, s72, v92
  v_mul_f32 v93, s72, v93
  v_mul_f32 v94, s72, v94
  s_waitcnt lgkmcnt(6)
  v_mfma_f32_32x32x16_bf16 v[32:47], v[24:27], v[132:135], v[32:47]
  ds_read_b64_tr_b16 v[24:25], v6 offset:12288
  ds_read_b64_tr_b16 v[26:27], v6 offset:13056
  v_mul_f32 v95, s72, v95
  v_cvt_pk_bf16_f32 v80, v80, v81
  v_cvt_pk_bf16_f32 v81, v82, v83
  v_cvt_pk_bf16_f32 v82, v84, v85
  v_cvt_pk_bf16_f32 v83, v86, v87
  s_waitcnt lgkmcnt(6)
  v_mfma_f32_32x32x16_bf16 v[48:63], v[28:31], v[132:135], v[48:63]
  ds_read_b64_tr_b16 v[28:29], v5 offset:12352
  ds_read_b64_tr_b16 v[30:31], v5 offset:13120
  v_cvt_pk_bf16_f32 v84, v88, v89
  v_cvt_pk_bf16_f32 v85, v90, v91
  v_cvt_pk_bf16_f32 v86, v92, v93
  v_cvt_pk_bf16_f32 v87, v94, v95
  buffer_store_dwordx4 v[80:83], v1, s[52:55], s68 offen sc1
  s_waitcnt lgkmcnt(6)
  v_mfma_f32_32x32x16_bf16 v[64:79], v[16:19], v[132:135], v[64:79]
  ds_read_b64_tr_b16 v[16:17], v5 offset:18432
  ds_read_b64_tr_b16 v[18:19], v5 offset:19200
  buffer_store_dwordx4 v[84:87], v1, s[52:55], s69 offen sc1
  v_mul_f32 v96, s72, v96
  v_mul_f32 v97, s72, v97
  v_mul_f32 v98, s72, v98
  v_mul_f32 v99, s72, v99
  s_waitcnt lgkmcnt(6)
  v_mfma_f32_32x32x16_bf16 v[32:47], v[20:23], v[136:139], v[32:47]
  ds_read_b64_tr_b16 v[20:21], v6 offset:18432
  ds_read_b64_tr_b16 v[22:23], v6 offset:19200
  v_mul_f32 v100, s72, v100
  v_mul_f32 v101, s72, v101
  v_mul_f32 v102, s72, v102
  v_mul_f32 v103, s72, v103
  v_mul_f32 v104, s72, v104
  s_waitcnt lgkmcnt(6)
  v_mfma_f32_32x32x16_bf16 v[48:63], v[24:27], v[136:139], v[48:63]
  ds_read_b64_tr_b16 v[24:25], v5 offset:18496
  ds_read_b64_tr_b16 v[26:27], v5 offset:19264
  v_mul_f32 v105, s72, v105
  v_mul_f32 v106, s72, v106
  v_mul_f32 v107, s72, v107
  v_mul_f32 v108, s72, v108
  v_mul_f32 v109, s72, v109
  s_waitcnt lgkmcnt(6)
  v_mfma_f32_32x32x16_bf16 v[64:79], v[28:31], v[136:139], v[64:79]
  ds_read_b64_tr_b16 v[28:29], v6 offset:64
  ds_read_b64_tr_b16 v[30:31], v6 offset:832
  v_mul_f32 v110, s72, v110
  v_mul_f32 v111, s72, v111
  v_cvt_pk_bf16_f32 v96, v96, v97
  v_cvt_pk_bf16_f32 v97, v98, v99
  v_cvt_pk_bf16_f32 v98, v100, v101
  s_waitcnt lgkmcnt(6)
  v_mfma_f32_32x32x16_bf16 v[32:47], v[16:19], v[140:143], v[32:47]
  ds_read_b64_tr_b16 v[16:17], v5 offset:128
  ds_read_b64_tr_b16 v[18:19], v5 offset:896
  v_cvt_pk_bf16_f32 v99, v102, v103
  v_cvt_pk_bf16_f32 v100, v104, v105
  v_cvt_pk_bf16_f32 v101, v106, v107
  v_cvt_pk_bf16_f32 v102, v108, v109
  v_cvt_pk_bf16_f32 v103, v110, v111
  s_waitcnt lgkmcnt(6)
  v_mfma_f32_32x32x16_bf16 v[48:63], v[20:23], v[140:143], v[48:63]
  ds_read_b64_tr_b16 v[20:21], v6 offset:128
  ds_read_b64_tr_b16 v[22:23], v6 offset:896
  buffer_store_dwordx4 v[96:99], v1, s[52:55], s70 offen sc1
  buffer_store_dwordx4 v[100:103], v1, s[52:55], s71 offen sc1
  v_cvt_pk_bf16_f32 v112, v112, v113
  v_cvt_pk_bf16_f32 v113, v114, v115
  v_cvt_pk_bf16_f32 v114, v116, v117
  s_waitcnt lgkmcnt(6)
  v_mfma_f32_32x32x16_bf16 v[64:79], v[24:27], v[140:143], v[64:79]
  ds_read_b64_tr_b16 v[24:25], v6 offset:6208
  ds_read_b64_tr_b16 v[26:27], v6 offset:6976
  v_cvt_pk_bf16_f32 v115, v118, v119
  v_cvt_pk_bf16_f32 v116, v120, v121
  v_cvt_pk_bf16_f32 v117, v122, v123
  v_cvt_pk_bf16_f32 v118, v124, v125
  v_cvt_pk_bf16_f32 v119, v126, v127
  s_waitcnt lgkmcnt(6)
  v_mfma_f32_32x32x16_bf16 v[80:95], v[28:31], v[128:131], 0
  ds_read_b64_tr_b16 v[28:29], v5 offset:6272
  ds_read_b64_tr_b16 v[30:31], v5 offset:7040
  buffer_store_dwordx4 v[112:115], v9, s[52:55], s73 offen sc1
  buffer_store_dwordx4 v[116:119], v9, s[52:55], s73 offen offset:512 sc1
  s_waitcnt lgkmcnt(6)
  v_mfma_f32_32x32x16_bf16 v[96:111], v[16:19], v[128:131], 0
  ds_read_b64_tr_b16 v[16:17], v6 offset:6272
  ds_read_b64_tr_b16 v[18:19], v6 offset:7040
  s_waitcnt lgkmcnt(6)
  v_mfma_f32_32x32x16_bf16 v[112:127], v[20:23], v[128:131], 0
  ds_read_b64_tr_b16 v[128:129], v6 offset:12352
  ds_read_b64_tr_b16 v[130:131], v6 offset:13120
  ds_read_b64_tr_b16 v[20:21], v5 offset:12416
  ds_read_b64_tr_b16 v[22:23], v5 offset:13184
  s_waitcnt lgkmcnt(8)
  v_mfma_f32_32x32x16_bf16 v[80:95], v[24:27], v[132:135], v[80:95]
  ds_read_b64_tr_b16 v[24:25], v6 offset:12416
  ds_read_b64_tr_b16 v[26:27], v6 offset:13184
  s_waitcnt lgkmcnt(8)
  v_mfma_f32_32x32x16_bf16 v[96:111], v[28:31], v[132:135], v[96:111]
  ds_read_b64_tr_b16 v[28:29], v6 offset:18496
  ds_read_b64_tr_b16 v[30:31], v6 offset:19264
  s_waitcnt lgkmcnt(8)
  v_mfma_f32_32x32x16_bf16 v[112:127], v[16:19], v[132:135], v[112:127]
  ds_read_b64_tr_b16 v[132:133], v5 offset:18560
  ds_read_b64_tr_b16 v[134:135], v5 offset:19328
  ds_read_b64_tr_b16 v[16:17], v6 offset:18560
  ds_read_b64_tr_b16 v[18:19], v6 offset:19328
  s_waitcnt lgkmcnt(10)
  v_mfma_f32_32x32x16_bf16 v[80:95], v[128:131], v[136:139], v[80:95]
  s_barrier
  ds_read_b64_tr_b16 v[128:129], v5 offset:24576
  ds_read_b64_tr_b16 v[130:131], v5 offset:25344
  s_waitcnt lgkmcnt(10)
  v_mfma_f32_32x32x16_bf16 v[96:111], v[20:23], v[136:139], v[96:111]
  ds_read_b64_tr_b16 v[20:21], v6 offset:24576
  ds_read_b64_tr_b16 v[22:23], v6 offset:25344
  s_waitcnt lgkmcnt(10)
  v_mfma_f32_32x32x16_bf16 v[112:127], v[24:27], v[136:139], v[112:127]
  ds_read_b64_tr_b16 v[136:137], v5 offset:24640
  ds_read_b64_tr_b16 v[138:139], v5 offset:25408
  s_waitcnt lgkmcnt(10)
  v_mfma_f32_32x32x16_bf16 v[80:95], v[28:31], v[140:143], v[80:95]
  ds_read_b64_tr_b16 v[24:25], v6 offset:24640
  ds_read_b64_tr_b16 v[26:27], v6 offset:25408
  s_waitcnt lgkmcnt(10)
  v_mfma_f32_32x32x16_bf16 v[96:111], v[132:135], v[140:143], v[96:111]
  ds_read_b64_tr_b16 v[28:29], v5 offset:24704
  ds_read_b64_tr_b16 v[30:31], v5 offset:25472
  s_waitcnt lgkmcnt(10)
  v_mfma_f32_32x32x16_bf16 v[112:127], v[16:19], v[140:143], v[112:127]
  ds_read_b64_tr_b16 v[140:141], v6 offset:24704
  ds_read_b64_tr_b16 v[142:143], v6 offset:25472
  s_waitcnt lgkmcnt(10)
  v_mfma_f32_32x32x16_bf16 v[32:47], v[128:131], v[144:147], v[32:47]
  ds_read_b64_tr_b16 v[132:133], v5 offset:30720
  ds_read_b64_tr_b16 v[134:135], v5 offset:31488
  s_waitcnt lgkmcnt(10)
  v_mfma_f32_32x32x16_bf16 v[48:63], v[20:23], v[144:147], v[48:63]
  ds_read_b64_tr_b16 v[16:17], v6 offset:30720
  ds_read_b64_tr_b16 v[18:19], v6 offset:31488
  s_waitcnt lgkmcnt(10)
  v_mfma_f32_32x32x16_bf16 v[64:79], v[136:139], v[144:147], v[64:79]
  ds_read_b64_tr_b16 v[128:129], v5 offset:30784
  ds_read_b64_tr_b16 v[130:131], v5 offset:31552
  s_and_b32 s62, s59, 3
  s_lshl_b32 s62, s62, 2
  s_lshr_b32 s63, s59, 2
  s_add_u32 s62, s62, s63
  s_waitcnt lgkmcnt(10)
  v_mfma_f32_32x32x16_bf16 v[80:95], v[24:27], v[144:147], v[80:95]
  ds_read_b64_tr_b16 v[20:21], v6 offset:30784
  ds_read_b64_tr_b16 v[22:23], v6 offset:31552
  s_lshl4_add_u32 s62, s62, s60
  s_mul_i32 s63, s56, 1024
  s_add_u32 s62, s62, s63
  s_lshl3_add_u32 s62, s62, 16269312
  s_waitcnt lgkmcnt(10)
  v_mfma_f32_32x32x16_bf16 v[96:111], v[28:31], v[144:147], v[96:111]
  ds_read_b64_tr_b16 v[136:137], v5 offset:30848
  ds_read_b64_tr_b16 v[138:139], v5 offset:31616
  v_mov_b32 v2, s100
  v_mov_b32 v3, s101
  v_lshlrev_b32 v4, 11, v0
  v_cmp_gt_u32 vcc, 4, v0
  s_waitcnt lgkmcnt(10)
  v_mfma_f32_32x32x16_bf16 v[112:127], v[140:143], v[144:147], v[112:127]
  ds_read_b64_tr_b16 v[24:25], v6 offset:30848
  ds_read_b64_tr_b16 v[26:27], v6 offset:31616
  v_mov_b32 v14, 16777216
  v_cndmask_b32 v4, v14, v4, vcc
  s_waitcnt lgkmcnt(10)
  v_mfma_f32_32x32x16_bf16 v[32:47], v[132:135], v[148:151], v[32:47]
  ds_read_b64_tr_b16 v[28:29], v5 offset:36864
  ds_read_b64_tr_b16 v[30:31], v5 offset:37632
  s_waitcnt lgkmcnt(10)
  v_mfma_f32_32x32x16_bf16 v[48:63], v[16:19], v[148:151], v[48:63]
  ds_read_b64_tr_b16 v[140:141], v6 offset:36864
  ds_read_b64_tr_b16 v[142:143], v6 offset:37632
  s_waitcnt lgkmcnt(10)
  v_mfma_f32_32x32x16_bf16 v[64:79], v[128:131], v[148:151], v[64:79]
  ds_read_b64_tr_b16 v[132:133], v5 offset:36928
  ds_read_b64_tr_b16 v[134:135], v5 offset:37696
  s_waitcnt lgkmcnt(10)
  v_mfma_f32_32x32x16_bf16 v[80:95], v[20:23], v[148:151], v[80:95]
  ds_read_b64_tr_b16 v[16:17], v6 offset:36928
  ds_read_b64_tr_b16 v[18:19], v6 offset:37696
  s_waitcnt lgkmcnt(10)
  v_mfma_f32_32x32x16_bf16 v[96:111], v[136:139], v[148:151], v[96:111]
  ds_read_b64_tr_b16 v[128:129], v5 offset:36992
  ds_read_b64_tr_b16 v[130:131], v5 offset:37760
  s_waitcnt lgkmcnt(10)
  v_mfma_f32_32x32x16_bf16 v[112:127], v[24:27], v[148:151], v[112:127]
  ds_read_b64_tr_b16 v[20:21], v6 offset:36992
  ds_read_b64_tr_b16 v[22:23], v6 offset:37760
  s_waitcnt lgkmcnt(10)
  v_mfma_f32_32x32x16_bf16 v[32:47], v[28:31], v[152:155], v[32:47]
  ds_read_b64_tr_b16 v[136:137], v5 offset:43008
  ds_read_b64_tr_b16 v[138:139], v5 offset:43776
  s_waitcnt lgkmcnt(10)
  v_mfma_f32_32x32x16_bf16 v[48:63], v[140:143], v[152:155], v[48:63]
  ds_read_b64_tr_b16 v[24:25], v6 offset:43008
  ds_read_b64_tr_b16 v[26:27], v6 offset:43776
  s_waitcnt lgkmcnt(10)
  v_mfma_f32_32x32x16_bf16 v[64:79], v[132:135], v[152:155], v[64:79]
  ds_read_b64_tr_b16 v[28:29], v5 offset:43072
  ds_read_b64_tr_b16 v[30:31], v5 offset:43840
  s_waitcnt lgkmcnt(10)
  v_mfma_f32_32x32x16_bf16 v[80:95], v[16:19], v[152:155], v[80:95]
  ds_read_b64_tr_b16 v[140:141], v6 offset:43072
  ds_read_b64_tr_b16 v[142:143], v6 offset:43840
  s_waitcnt lgkmcnt(10)
  v_mfma_f32_32x32x16_bf16 v[96:111], v[128:131], v[152:155], v[96:111]
  ds_read_b64_tr_b16 v[132:133], v5 offset:43136
  ds_read_b64_tr_b16 v[134:135], v5 offset:43904
  s_waitcnt lgkmcnt(10)
  v_mfma_f32_32x32x16_bf16 v[112:127], v[20:23], v[152:155], v[112:127]
  ds_read_b64_tr_b16 v[16:17], v6 offset:43136
  ds_read_b64_tr_b16 v[18:19], v6 offset:43904
  s_waitcnt lgkmcnt(10)
  v_mfma_f32_32x32x16_bf16 v[32:47], v[136:139], v[156:159], v[32:47]
  s_barrier
  v_subrev_u32 v5, 114688, v5
  v_subrev_u32 v6, 114688, v6
  ds_read_b64_tr_b16 v[128:129], v5 offset:0
  ds_read_b64_tr_b16 v[130:131], v5 offset:768
  s_waitcnt lgkmcnt(10)
  v_mfma_f32_32x32x16_bf16 v[48:63], v[24:27], v[156:159], v[48:63]
  ds_read_b64_tr_b16 v[20:21], v6 offset:0
  ds_read_b64_tr_b16 v[22:23], v6 offset:768
  s_waitcnt lgkmcnt(10)
  v_mfma_f32_32x32x16_bf16 v[64:79], v[28:31], v[156:159], v[64:79]
  ds_read_b64_tr_b16 v[136:137], v5 offset:64
  ds_read_b64_tr_b16 v[138:139], v5 offset:832
  s_waitcnt lgkmcnt(10)
  v_mfma_f32_32x32x16_bf16 v[80:95], v[140:143], v[156:159], v[80:95]
  ds_read_b64_tr_b16 v[24:25], v6 offset:64
  ds_read_b64_tr_b16 v[26:27], v6 offset:832
  s_waitcnt lgkmcnt(10)
  v_mfma_f32_32x32x16_bf16 v[96:111], v[132:135], v[156:159], v[96:111]
  ds_read_b64_tr_b16 v[28:29], v5 offset:128
  ds_read_b64_tr_b16 v[30:31], v5 offset:896
  s_waitcnt lgkmcnt(10)
  v_mfma_f32_32x32x16_bf16 v[112:127], v[16:19], v[156:159], v[112:127]
  ds_read_b64_tr_b16 v[140:141], v6 offset:128
  ds_read_b64_tr_b16 v[142:143], v6 offset:896
  s_waitcnt lgkmcnt(10)
  v_mfma_f32_32x32x16_bf16 v[32:47], v[128:131], v[160:163], v[32:47]
  ds_read_b64_tr_b16 v[132:133], v5 offset:6144
  ds_read_b64_tr_b16 v[134:135], v5 offset:6912
  s_waitcnt lgkmcnt(10)
  v_mfma_f32_32x32x16_bf16 v[48:63], v[20:23], v[160:163], v[48:63]
  ds_read_b64_tr_b16 v[16:17], v6 offset:6144
  ds_read_b64_tr_b16 v[18:19], v6 offset:6912
  s_waitcnt lgkmcnt(10)
  v_mfma_f32_32x32x16_bf16 v[64:79], v[136:139], v[160:163], v[64:79]
  ds_read_b64_tr_b16 v[128:129], v5 offset:6208
  ds_read_b64_tr_b16 v[130:131], v5 offset:6976
  s_waitcnt lgkmcnt(10)
  v_mfma_f32_32x32x16_bf16 v[80:95], v[24:27], v[160:163], v[80:95]
  ds_read_b64_tr_b16 v[20:21], v6 offset:6208
  ds_read_b64_tr_b16 v[22:23], v6 offset:6976
  s_waitcnt lgkmcnt(10)
  v_mfma_f32_32x32x16_bf16 v[96:111], v[28:31], v[160:163], v[96:111]
  ds_read_b64_tr_b16 v[136:137], v5 offset:6272
  ds_read_b64_tr_b16 v[138:139], v5 offset:7040
  s_waitcnt lgkmcnt(10)
  v_mfma_f32_32x32x16_bf16 v[112:127], v[140:143], v[160:163], v[112:127]
  ds_read_b64_tr_b16 v[24:25], v6 offset:6272
  ds_read_b64_tr_b16 v[26:27], v6 offset:7040
  s_waitcnt lgkmcnt(10)
  v_mfma_f32_32x32x16_bf16 v[32:47], v[132:135], v[164:167], v[32:47]
  ds_read_b64_tr_b16 v[28:29], v5 offset:12288
  ds_read_b64_tr_b16 v[30:31], v5 offset:13056
  s_waitcnt lgkmcnt(10)
  v_mfma_f32_32x32x16_bf16 v[48:63], v[16:19], v[164:167], v[48:63]
  ds_read_b64_tr_b16 v[140:141], v6 offset:12288
  ds_read_b64_tr_b16 v[142:143], v6 offset:13056
  s_waitcnt lgkmcnt(10)
  v_mfma_f32_32x32x16_bf16 v[64:79], v[128:131], v[164:167], v[64:79]
  ds_read_b64_tr_b16 v[132:133], v5 offset:12352
  ds_read_b64_tr_b16 v[134:135], v5 offset:13120
  s_waitcnt lgkmcnt(10)
  v_mfma_f32_32x32x16_bf16 v[80:95], v[20:23], v[164:167], v[80:95]
  ds_read_b64_tr_b16 v[16:17], v6 offset:12352
  ds_read_b64_tr_b16 v[18:19], v6 offset:13120
  s_waitcnt lgkmcnt(10)
  v_mfma_f32_32x32x16_bf16 v[96:111], v[136:139], v[164:167], v[96:111]
  ds_read_b64_tr_b16 v[128:129], v5 offset:12416
  ds_read_b64_tr_b16 v[130:131], v5 offset:13184
  s_waitcnt lgkmcnt(10)
  v_mfma_f32_32x32x16_bf16 v[112:127], v[24:27], v[164:167], v[112:127]
  ds_read_b64_tr_b16 v[20:21], v6 offset:12416
  ds_read_b64_tr_b16 v[22:23], v6 offset:13184
  s_waitcnt lgkmcnt(10)
  v_mfma_f32_32x32x16_bf16 v[32:47], v[28:31], v[168:171], v[32:47]
  ds_read_b64_tr_b16 v[136:137], v5 offset:18432
  ds_read_b64_tr_b16 v[138:139], v5 offset:19200
  s_waitcnt lgkmcnt(10)
  v_mfma_f32_32x32x16_bf16 v[48:63], v[140:143], v[168:171], v[48:63]
  ds_read_b64_tr_b16 v[24:25], v6 offset:18432
  ds_read_b64_tr_b16 v[26:27], v6 offset:19200
  s_waitcnt lgkmcnt(10)
  v_mfma_f32_32x32x16_bf16 v[64:79], v[132:135], v[168:171], v[64:79]
  ds_read_b64_tr_b16 v[28:29], v5 offset:18496
  ds_read_b64_tr_b16 v[30:31], v5 offset:19264
  s_waitcnt lgkmcnt(10)
  v_mfma_f32_32x32x16_bf16 v[80:95], v[16:19], v[168:171], v[80:95]
  ds_read_b64_tr_b16 v[140:141], v6 offset:18496
  ds_read_b64_tr_b16 v[142:143], v6 offset:19264
  s_waitcnt lgkmcnt(10)
  v_mfma_f32_32x32x16_bf16 v[96:111], v[128:131], v[168:171], v[96:111]
  ds_read_b64_tr_b16 v[132:133], v5 offset:18560
  ds_read_b64_tr_b16 v[134:135], v5 offset:19328
  s_waitcnt lgkmcnt(10)
  v_mfma_f32_32x32x16_bf16 v[112:127], v[20:23], v[168:171], v[112:127]
  ds_read_b64_tr_b16 v[16:17], v6 offset:18560
  ds_read_b64_tr_b16 v[18:19], v6 offset:19328
  s_waitcnt lgkmcnt(10)
  v_mfma_f32_32x32x16_bf16 v[32:47], v[136:139], v[172:175], v[32:47]
  s_waitcnt vmcnt(0)
  s_barrier
  buffer_store_dwordx2 v[2:3], v4, s[52:55], s62 offen sc1
  ds_read_b64_tr_b16 v[128:129], v5 offset:24576
  ds_read_b64_tr_b16 v[130:131], v5 offset:25344
  s_waitcnt lgkmcnt(10)
  v_mfma_f32_32x32x16_bf16 v[48:63], v[24:27], v[172:175], v[48:63]
  ds_read_b64_tr_b16 v[20:21], v6 offset:24576
  ds_read_b64_tr_b16 v[22:23], v6 offset:25344
  s_waitcnt lgkmcnt(10)
  v_mfma_f32_32x32x16_bf16 v[64:79], v[28:31], v[172:175], v[64:79]
  ds_read_b64_tr_b16 v[136:137], v5 offset:24640
  ds_read_b64_tr_b16 v[138:139], v5 offset:25408
  s_waitcnt lgkmcnt(10)
  v_mfma_f32_32x32x16_bf16 v[80:95], v[140:143], v[172:175], v[80:95]
  ds_read_b64_tr_b16 v[24:25], v6 offset:24640
  ds_read_b64_tr_b16 v[26:27], v6 offset:25408
  s_waitcnt lgkmcnt(10)
  v_mfma_f32_32x32x16_bf16 v[96:111], v[132:135], v[172:175], v[96:111]
  ds_read_b64_tr_b16 v[28:29], v5 offset:24704
  ds_read_b64_tr_b16 v[30:31], v5 offset:25472
  s_waitcnt lgkmcnt(10)
  v_mfma_f32_32x32x16_bf16 v[112:127], v[16:19], v[172:175], v[112:127]
  ds_read_b64_tr_b16 v[140:141], v6 offset:24704
  ds_read_b64_tr_b16 v[142:143], v6 offset:25472
  s_waitcnt lgkmcnt(10)
  v_mfma_f32_32x32x16_bf16 v[32:47], v[128:131], v[176:179], v[32:47]
  ds_read_b64_tr_b16 v[132:133], v5 offset:30720
  ds_read_b64_tr_b16 v[134:135], v5 offset:31488
  s_waitcnt lgkmcnt(10)
  v_mfma_f32_32x32x16_bf16 v[48:63], v[20:23], v[176:179], v[48:63]
  ds_read_b64_tr_b16 v[16:17], v6 offset:30720
  ds_read_b64_tr_b16 v[18:19], v6 offset:31488
  s_waitcnt lgkmcnt(10)
  v_mfma_f32_32x32x16_bf16 v[64:79], v[136:139], v[176:179], v[64:79]
  ds_read_b64_tr_b16 v[128:129], v5 offset:30784
  ds_read_b64_tr_b16 v[130:131], v5 offset:31552
  s_waitcnt lgkmcnt(10)
  v_mfma_f32_32x32x16_bf16 v[80:95], v[24:27], v[176:179], v[80:95]
  ds_read_b64_tr_b16 v[20:21], v6 offset:30784
  ds_read_b64_tr_b16 v[22:23], v6 offset:31552
  s_waitcnt lgkmcnt(10)
  v_mfma_f32_32x32x16_bf16 v[96:111], v[28:31], v[176:179], v[96:111]
  ds_read_b64_tr_b16 v[136:137], v5 offset:30848
  ds_read_b64_tr_b16 v[138:139], v5 offset:31616
  s_waitcnt lgkmcnt(10)
  v_mfma_f32_32x32x16_bf16 v[112:127], v[140:143], v[176:179], v[112:127]
  ds_read_b64_tr_b16 v[24:25], v6 offset:30848
  ds_read_b64_tr_b16 v[26:27], v6 offset:31616
  s_waitcnt lgkmcnt(10)
  v_mfma_f32_32x32x16_bf16 v[32:47], v[132:135], v[180:183], v[32:47]
  ds_read_b64_tr_b16 v[28:29], v5 offset:36864
  ds_read_b64_tr_b16 v[30:31], v5 offset:37632
  s_waitcnt lgkmcnt(10)
  v_mfma_f32_32x32x16_bf16 v[48:63], v[16:19], v[180:183], v[48:63]
  ds_read_b64_tr_b16 v[140:141], v6 offset:36864
  ds_read_b64_tr_b16 v[142:143], v6 offset:37632
  s_waitcnt lgkmcnt(10)
  v_mfma_f32_32x32x16_bf16 v[64:79], v[128:131], v[180:183], v[64:79]
  ds_read_b64_tr_b16 v[132:133], v5 offset:36928
  ds_read_b64_tr_b16 v[134:135], v5 offset:37696
  s_waitcnt lgkmcnt(10)
  v_mfma_f32_32x32x16_bf16 v[80:95], v[20:23], v[180:183], v[80:95]
  ds_read_b64_tr_b16 v[16:17], v6 offset:36928
  ds_read_b64_tr_b16 v[18:19], v6 offset:37696
  s_waitcnt lgkmcnt(10)
  v_mfma_f32_32x32x16_bf16 v[96:111], v[136:139], v[180:183], v[96:111]
  ds_read_b64_tr_b16 v[128:129], v5 offset:36992
  ds_read_b64_tr_b16 v[130:131], v5 offset:37760
  s_waitcnt lgkmcnt(10)
  v_mfma_f32_32x32x16_bf16 v[112:127], v[24:27], v[180:183], v[112:127]
  ds_read_b64_tr_b16 v[20:21], v6 offset:36992
  ds_read_b64_tr_b16 v[22:23], v6 offset:37760
  s_waitcnt lgkmcnt(10)
  v_mfma_f32_32x32x16_bf16 v[32:47], v[28:31], v[184:187], v[32:47]
  ds_read_b64_tr_b16 v[136:137], v5 offset:43008
  ds_read_b64_tr_b16 v[138:139], v5 offset:43776
  s_waitcnt lgkmcnt(10)
  v_mfma_f32_32x32x16_bf16 v[48:63], v[140:143], v[184:187], v[48:63]
  ds_read_b64_tr_b16 v[24:25], v6 offset:43008
  ds_read_b64_tr_b16 v[26:27], v6 offset:43776
  s_waitcnt lgkmcnt(10)
  v_mfma_f32_32x32x16_bf16 v[64:79], v[132:135], v[184:187], v[64:79]
  ds_read_b64_tr_b16 v[28:29], v5 offset:43072
  ds_read_b64_tr_b16 v[30:31], v5 offset:43840
  s_waitcnt lgkmcnt(10)
  v_mfma_f32_32x32x16_bf16 v[80:95], v[16:19], v[184:187], v[80:95]
  ds_read_b64_tr_b16 v[140:141], v6 offset:43072
  ds_read_b64_tr_b16 v[142:143], v6 offset:43840
  s_waitcnt lgkmcnt(10)
  v_mfma_f32_32x32x16_bf16 v[96:111], v[128:131], v[184:187], v[96:111]
  ds_read_b64_tr_b16 v[132:133], v5 offset:43136
  ds_read_b64_tr_b16 v[134:135], v5 offset:43904
  s_waitcnt lgkmcnt(10)
  v_mfma_f32_32x32x16_bf16 v[112:127], v[20:23], v[184:187], v[112:127]
  ds_read_b64_tr_b16 v[16:17], v6 offset:43136
  ds_read_b64_tr_b16 v[18:19], v6 offset:43904
  s_waitcnt lgkmcnt(10)
  v_mfma_f32_32x32x16_bf16 v[32:47], v[136:139], v[188:191], v[32:47]
  s_barrier
  v_add_u32 v5, 49152, v5
  v_add_u32 v6, 49152, v6
  ds_read_b64_tr_b16 v[128:129], v5 offset:0
  ds_read_b64_tr_b16 v[130:131], v5 offset:768
  s_waitcnt lgkmcnt(10)
  v_mfma_f32_32x32x16_bf16 v[48:63], v[24:27], v[188:191], v[48:63]
  ds_read_b64_tr_b16 v[20:21], v6 offset:0
  ds_read_b64_tr_b16 v[22:23], v6 offset:768
  s_waitcnt lgkmcnt(10)
  v_mfma_f32_32x32x16_bf16 v[64:79], v[28:31], v[188:191], v[64:79]
  ds_read_b64_tr_b16 v[136:137], v5 offset:64
  ds_read_b64_tr_b16 v[138:139], v5 offset:832
  s_waitcnt lgkmcnt(10)
  v_mfma_f32_32x32x16_bf16 v[80:95], v[140:143], v[188:191], v[80:95]
  ds_read_b64_tr_b16 v[24:25], v6 offset:64
  ds_read_b64_tr_b16 v[26:27], v6 offset:832
  s_waitcnt lgkmcnt(10)
  v_mfma_f32_32x32x16_bf16 v[96:111], v[132:135], v[188:191], v[96:111]
  ds_read_b64_tr_b16 v[28:29], v5 offset:128
  ds_read_b64_tr_b16 v[30:31], v5 offset:896
  s_waitcnt lgkmcnt(10)
  v_mfma_f32_32x32x16_bf16 v[112:127], v[16:19], v[188:191], v[112:127]
  ds_read_b64_tr_b16 v[140:141], v6 offset:128
  ds_read_b64_tr_b16 v[142:143], v6 offset:896
  s_waitcnt lgkmcnt(10)
  v_mfma_f32_32x32x16_bf16 v[32:47], v[128:131], v[192:195], v[32:47]
  ds_read_b64_tr_b16 v[132:133], v5 offset:6144
  ds_read_b64_tr_b16 v[134:135], v5 offset:6912
  s_waitcnt lgkmcnt(10)
  v_mfma_f32_32x32x16_bf16 v[48:63], v[20:23], v[192:195], v[48:63]
  ds_read_b64_tr_b16 v[16:17], v6 offset:6144
  ds_read_b64_tr_b16 v[18:19], v6 offset:6912
  s_waitcnt lgkmcnt(10)
  v_mfma_f32_32x32x16_bf16 v[64:79], v[136:139], v[192:195], v[64:79]
  ds_read_b64_tr_b16 v[128:129], v5 offset:6208
  ds_read_b64_tr_b16 v[130:131], v5 offset:6976
  s_waitcnt lgkmcnt(10)
  v_mfma_f32_32x32x16_bf16 v[80:95], v[24:27], v[192:195], v[80:95]
  ds_read_b64_tr_b16 v[20:21], v6 offset:6208
  ds_read_b64_tr_b16 v[22:23], v6 offset:6976
  s_waitcnt lgkmcnt(10)
  v_mfma_f32_32x32x16_bf16 v[96:111], v[28:31], v[192:195], v[96:111]
  ds_read_b64_tr_b16 v[136:137], v5 offset:6272
  ds_read_b64_tr_b16 v[138:139], v5 offset:7040
  s_waitcnt lgkmcnt(10)
  v_mfma_f32_32x32x16_bf16 v[112:127], v[140:143], v[192:195], v[112:127]
  ds_read_b64_tr_b16 v[24:25], v6 offset:6272
  ds_read_b64_tr_b16 v[26:27], v6 offset:7040
  s_waitcnt lgkmcnt(10)
  v_mfma_f32_32x32x16_bf16 v[32:47], v[132:135], v[196:199], v[32:47]
  ds_read_b64_tr_b16 v[28:29], v5 offset:12288
  ds_read_b64_tr_b16 v[30:31], v5 offset:13056
  s_waitcnt lgkmcnt(10)
  v_mfma_f32_32x32x16_bf16 v[48:63], v[16:19], v[196:199], v[48:63]
  ds_read_b64_tr_b16 v[140:141], v6 offset:12288
  ds_read_b64_tr_b16 v[142:143], v6 offset:13056
  s_waitcnt lgkmcnt(10)
  v_mfma_f32_32x32x16_bf16 v[64:79], v[128:131], v[196:199], v[64:79]
  ds_read_b64_tr_b16 v[132:133], v5 offset:12352
  ds_read_b64_tr_b16 v[134:135], v5 offset:13120
  s_waitcnt lgkmcnt(10)
  v_mfma_f32_32x32x16_bf16 v[80:95], v[20:23], v[196:199], v[80:95]
  ds_read_b64_tr_b16 v[16:17], v6 offset:12352
  ds_read_b64_tr_b16 v[18:19], v6 offset:13120
  s_waitcnt lgkmcnt(10)
  v_mfma_f32_32x32x16_bf16 v[96:111], v[136:139], v[196:199], v[96:111]
  ds_read_b64_tr_b16 v[128:129], v5 offset:12416
  ds_read_b64_tr_b16 v[130:131], v5 offset:13184
  s_waitcnt lgkmcnt(10)
  v_mfma_f32_32x32x16_bf16 v[112:127], v[24:27], v[196:199], v[112:127]
  ds_read_b64_tr_b16 v[20:21], v6 offset:12416
  ds_read_b64_tr_b16 v[22:23], v6 offset:13184
  s_waitcnt lgkmcnt(10)
  v_mfma_f32_32x32x16_bf16 v[32:47], v[28:31], v[200:203], v[32:47]
  ds_read_b64_tr_b16 v[136:137], v5 offset:18432
  ds_read_b64_tr_b16 v[138:139], v5 offset:19200
  s_waitcnt lgkmcnt(10)
  v_mfma_f32_32x32x16_bf16 v[48:63], v[140:143], v[200:203], v[48:63]
  ds_read_b64_tr_b16 v[24:25], v6 offset:18432
  ds_read_b64_tr_b16 v[26:27], v6 offset:19200
  s_waitcnt lgkmcnt(10)
  v_mfma_f32_32x32x16_bf16 v[64:79], v[132:135], v[200:203], v[64:79]
  ds_read_b64_tr_b16 v[28:29], v5 offset:18496
  ds_read_b64_tr_b16 v[30:31], v5 offset:19264
  s_waitcnt lgkmcnt(10)
  v_mfma_f32_32x32x16_bf16 v[80:95], v[16:19], v[200:203], v[80:95]
  ds_read_b64_tr_b16 v[140:141], v6 offset:18496
  ds_read_b64_tr_b16 v[142:143], v6 offset:19264
  s_waitcnt lgkmcnt(10)
  v_mfma_f32_32x32x16_bf16 v[96:111], v[128:131], v[200:203], v[96:111]
  ds_read_b64_tr_b16 v[132:133], v5 offset:18560
  ds_read_b64_tr_b16 v[134:135], v5 offset:19328
  s_waitcnt lgkmcnt(10)
  v_mfma_f32_32x32x16_bf16 v[112:127], v[20:23], v[200:203], v[112:127]
  ds_read_b64_tr_b16 v[16:17], v6 offset:18560
  ds_read_b64_tr_b16 v[18:19], v6 offset:19328
  s_waitcnt lgkmcnt(10)
  v_mfma_f32_32x32x16_bf16 v[32:47], v[136:139], v[204:207], v[32:47]
  s_barrier
  ds_read_b64_tr_b16 v[128:129], v5 offset:24576
  ds_read_b64_tr_b16 v[130:131], v5 offset:25344
  s_waitcnt lgkmcnt(10)
  v_mfma_f32_32x32x16_bf16 v[48:63], v[24:27], v[204:207], v[48:63]
  ds_read_b64_tr_b16 v[20:21], v6 offset:24576
  ds_read_b64_tr_b16 v[22:23], v6 offset:25344
  s_waitcnt lgkmcnt(10)
  v_mfma_f32_32x32x16_bf16 v[64:79], v[28:31], v[204:207], v[64:79]
  ds_read_b64_tr_b16 v[136:137], v5 offset:24640
  ds_read_b64_tr_b16 v[138:139], v5 offset:25408
  s_waitcnt lgkmcnt(10)
  v_mfma_f32_32x32x16_bf16 v[80:95], v[140:143], v[204:207], v[80:95]
  ds_read_b64_tr_b16 v[24:25], v6 offset:24640
  ds_read_b64_tr_b16 v[26:27], v6 offset:25408
  s_waitcnt lgkmcnt(10)
  v_mfma_f32_32x32x16_bf16 v[96:111], v[132:135], v[204:207], v[96:111]
  ds_read_b64_tr_b16 v[28:29], v5 offset:24704
  ds_read_b64_tr_b16 v[30:31], v5 offset:25472
  s_waitcnt lgkmcnt(10)
  v_mfma_f32_32x32x16_bf16 v[112:127], v[16:19], v[204:207], v[112:127]
  ds_read_b64_tr_b16 v[140:141], v6 offset:24704
  ds_read_b64_tr_b16 v[142:143], v6 offset:25472
  s_waitcnt lgkmcnt(10)
  v_mfma_f32_32x32x16_bf16 v[32:47], v[128:131], v[208:211], v[32:47]
  ds_read_b64_tr_b16 v[132:133], v5 offset:30720
  ds_read_b64_tr_b16 v[134:135], v5 offset:31488
  s_waitcnt lgkmcnt(10)
  v_mfma_f32_32x32x16_bf16 v[48:63], v[20:23], v[208:211], v[48:63]
  ds_read_b64_tr_b16 v[16:17], v6 offset:30720
  ds_read_b64_tr_b16 v[18:19], v6 offset:31488
  s_waitcnt lgkmcnt(10)
  v_mfma_f32_32x32x16_bf16 v[64:79], v[136:139], v[208:211], v[64:79]
  ds_read_b64_tr_b16 v[128:129], v5 offset:30784
  ds_read_b64_tr_b16 v[130:131], v5 offset:31552
  s_waitcnt lgkmcnt(10)
  v_mfma_f32_32x32x16_bf16 v[80:95], v[24:27], v[208:211], v[80:95]
  ds_read_b64_tr_b16 v[20:21], v6 offset:30784
  ds_read_b64_tr_b16 v[22:23], v6 offset:31552
  s_waitcnt lgkmcnt(10)
  v_mfma_f32_32x32x16_bf16 v[96:111], v[28:31], v[208:211], v[96:111]
  ds_read_b64_tr_b16 v[136:137], v5 offset:30848
  ds_read_b64_tr_b16 v[138:139], v5 offset:31616
  s_waitcnt lgkmcnt(10)
  v_mfma_f32_32x32x16_bf16 v[112:127], v[140:143], v[208:211], v[112:127]
  ds_read_b64_tr_b16 v[24:25], v6 offset:30848
  ds_read_b64_tr_b16 v[26:27], v6 offset:31616
  s_waitcnt lgkmcnt(10)
  v_mfma_f32_32x32x16_bf16 v[32:47], v[132:135], v[212:215], v[32:47]
  ds_read_b64_tr_b16 v[28:29], v5 offset:36864
  ds_read_b64_tr_b16 v[30:31], v5 offset:37632
  s_waitcnt lgkmcnt(10)
  v_mfma_f32_32x32x16_bf16 v[48:63], v[16:19], v[212:215], v[48:63]
  ds_read_b64_tr_b16 v[140:141], v6 offset:36864
  ds_read_b64_tr_b16 v[142:143], v6 offset:37632
  s_waitcnt lgkmcnt(10)
  v_mfma_f32_32x32x16_bf16 v[64:79], v[128:131], v[212:215], v[64:79]
  ds_read_b64_tr_b16 v[132:133], v5 offset:36928
  ds_read_b64_tr_b16 v[134:135], v5 offset:37696
  s_waitcnt lgkmcnt(10)
  v_mfma_f32_32x32x16_bf16 v[80:95], v[20:23], v[212:215], v[80:95]
  ds_read_b64_tr_b16 v[16:17], v6 offset:36928
  ds_read_b64_tr_b16 v[18:19], v6 offset:37696
  s_waitcnt lgkmcnt(10)
  v_mfma_f32_32x32x16_bf16 v[96:111], v[136:139], v[212:215], v[96:111]
  ds_read_b64_tr_b16 v[128:129], v5 offset:36992
  ds_read_b64_tr_b16 v[130:131], v5 offset:37760
  s_waitcnt lgkmcnt(10)
  v_mfma_f32_32x32x16_bf16 v[112:127], v[24:27], v[212:215], v[112:127]
  ds_read_b64_tr_b16 v[20:21], v6 offset:36992
  ds_read_b64_tr_b16 v[22:23], v6 offset:37760
  s_waitcnt lgkmcnt(10)
  v_mfma_f32_32x32x16_bf16 v[32:47], v[28:31], v[216:219], v[32:47]
  ds_read_b64_tr_b16 v[136:137], v5 offset:43008
  ds_read_b64_tr_b16 v[138:139], v5 offset:43776
  s_waitcnt lgkmcnt(10)
  v_mfma_f32_32x32x16_bf16 v[48:63], v[140:143], v[216:219], v[48:63]
  ds_read_b64_tr_b16 v[24:25], v6 offset:43008
  ds_read_b64_tr_b16 v[26:27], v6 offset:43776
  s_waitcnt lgkmcnt(10)
  v_mfma_f32_32x32x16_bf16 v[64:79], v[132:135], v[216:219], v[64:79]
  ds_read_b64_tr_b16 v[28:29], v5 offset:43072
  ds_read_b64_tr_b16 v[30:31], v5 offset:43840
  s_waitcnt lgkmcnt(10)
  v_mfma_f32_32x32x16_bf16 v[80:95], v[16:19], v[216:219], v[80:95]
  ds_read_b64_tr_b16 v[140:141], v6 offset:43072
  ds_read_b64_tr_b16 v[142:143], v6 offset:43840
  s_waitcnt lgkmcnt(10)
  v_mfma_f32_32x32x16_bf16 v[96:111], v[128:131], v[216:219], v[96:111]
  ds_read_b64_tr_b16 v[132:133], v5 offset:43136
  ds_read_b64_tr_b16 v[134:135], v5 offset:43904
  s_waitcnt lgkmcnt(10)
  v_mfma_f32_32x32x16_bf16 v[112:127], v[20:23], v[216:219], v[112:127]
  ds_read_b64_tr_b16 v[16:17], v6 offset:43136
  ds_read_b64_tr_b16 v[18:19], v6 offset:43904
  s_waitcnt lgkmcnt(10)
  v_mfma_f32_32x32x16_bf16 v[32:47], v[136:139], v[220:223], v[32:47]
  v_add_u32 v5, 65536, v5
  v_add_u32 v6, 65536, v6
  ds_read_b64_tr_b16 v[128:129], v5 offset:0
  ds_read_b64_tr_b16 v[130:131], v5 offset:768
  s_waitcnt lgkmcnt(10)
  v_mfma_f32_32x32x16_bf16 v[48:63], v[24:27], v[220:223], v[48:63]
  ds_read_b64_tr_b16 v[20:21], v6 offset:0
  ds_read_b64_tr_b16 v[22:23], v6 offset:768
  s_waitcnt lgkmcnt(10)
  v_mfma_f32_32x32x16_bf16 v[64:79], v[28:31], v[220:223], v[64:79]
  ds_read_b64_tr_b16 v[136:137], v5 offset:64
  ds_read_b64_tr_b16 v[138:139], v5 offset:832
  s_waitcnt lgkmcnt(10)
  v_mfma_f32_32x32x16_bf16 v[80:95], v[140:143], v[220:223], v[80:95]
  ds_read_b64_tr_b16 v[24:25], v6 offset:64
  ds_read_b64_tr_b16 v[26:27], v6 offset:832
  s_waitcnt lgkmcnt(10)
  v_mfma_f32_32x32x16_bf16 v[96:111], v[132:135], v[220:223], v[96:111]
  ds_read_b64_tr_b16 v[28:29], v5 offset:128
  ds_read_b64_tr_b16 v[30:31], v5 offset:896
  s_waitcnt lgkmcnt(10)
  v_mfma_f32_32x32x16_bf16 v[112:127], v[16:19], v[220:223], v[112:127]
  ds_read_b64_tr_b16 v[140:141], v6 offset:128
  ds_read_b64_tr_b16 v[142:143], v6 offset:896
  s_waitcnt lgkmcnt(10)
  v_mfma_f32_32x32x16_bf16 v[32:47], v[128:131], v[224:227], v[32:47]
  ds_read_b64_tr_b16 v[132:133], v5 offset:6144
  ds_read_b64_tr_b16 v[134:135], v5 offset:6912
  s_waitcnt lgkmcnt(10)
  v_mfma_f32_32x32x16_bf16 v[48:63], v[20:23], v[224:227], v[48:63]
  ds_read_b64_tr_b16 v[16:17], v6 offset:6144
  ds_read_b64_tr_b16 v[18:19], v6 offset:6912
  s_waitcnt lgkmcnt(10)
  v_mfma_f32_32x32x16_bf16 v[64:79], v[136:139], v[224:227], v[64:79]
  ds_read_b64_tr_b16 v[128:129], v5 offset:6208
  ds_read_b64_tr_b16 v[130:131], v5 offset:6976
  s_waitcnt lgkmcnt(10)
  v_mfma_f32_32x32x16_bf16 v[80:95], v[24:27], v[224:227], v[80:95]
  ds_read_b64_tr_b16 v[20:21], v6 offset:6208
  ds_read_b64_tr_b16 v[22:23], v6 offset:6976
  s_waitcnt lgkmcnt(10)
  v_mfma_f32_32x32x16_bf16 v[96:111], v[28:31], v[224:227], v[96:111]
  ds_read_b64_tr_b16 v[136:137], v5 offset:6272
  ds_read_b64_tr_b16 v[138:139], v5 offset:7040
  s_waitcnt lgkmcnt(10)
  v_mfma_f32_32x32x16_bf16 v[112:127], v[140:143], v[224:227], v[112:127]
  ds_read_b64_tr_b16 v[24:25], v6 offset:6272
  ds_read_b64_tr_b16 v[26:27], v6 offset:7040
  s_waitcnt lgkmcnt(10)
  v_mfma_f32_32x32x16_bf16 v[32:47], v[132:135], v[228:231], v[32:47]
  ds_read_b64_tr_b16 v[28:29], v5 offset:12288
  ds_read_b64_tr_b16 v[30:31], v5 offset:13056
  s_waitcnt lgkmcnt(10)
  v_mfma_f32_32x32x16_bf16 v[48:63], v[16:19], v[228:231], v[48:63]
  ds_read_b64_tr_b16 v[140:141], v6 offset:12288
  ds_read_b64_tr_b16 v[142:143], v6 offset:13056
  s_waitcnt lgkmcnt(10)
  v_mfma_f32_32x32x16_bf16 v[64:79], v[128:131], v[228:231], v[64:79]
  ds_read_b64_tr_b16 v[132:133], v5 offset:12352
  ds_read_b64_tr_b16 v[134:135], v5 offset:13120
  s_waitcnt lgkmcnt(10)
  v_mfma_f32_32x32x16_bf16 v[80:95], v[20:23], v[228:231], v[80:95]
  ds_read_b64_tr_b16 v[16:17], v6 offset:12352
  ds_read_b64_tr_b16 v[18:19], v6 offset:13120
  s_waitcnt lgkmcnt(10)
  v_mfma_f32_32x32x16_bf16 v[96:111], v[136:139], v[228:231], v[96:111]
  ds_read_b64_tr_b16 v[128:129], v5 offset:12416
  ds_read_b64_tr_b16 v[130:131], v5 offset:13184
  s_waitcnt lgkmcnt(10)
  v_mfma_f32_32x32x16_bf16 v[112:127], v[24:27], v[228:231], v[112:127]
  ds_read_b64_tr_b16 v[20:21], v6 offset:12416
  ds_read_b64_tr_b16 v[22:23], v6 offset:13184
  s_waitcnt lgkmcnt(10)
  v_mfma_f32_32x32x16_bf16 v[32:47], v[28:31], v[232:235], v[32:47]
  ds_read_b64_tr_b16 v[136:137], v5 offset:18432
  ds_read_b64_tr_b16 v[138:139], v5 offset:19200
  s_waitcnt lgkmcnt(10)
  v_mfma_f32_32x32x16_bf16 v[48:63], v[140:143], v[232:235], v[48:63]
  ds_read_b64_tr_b16 v[24:25], v6 offset:18432
  ds_read_b64_tr_b16 v[26:27], v6 offset:19200
  s_waitcnt lgkmcnt(10)
  v_mfma_f32_32x32x16_bf16 v[64:79], v[132:135], v[232:235], v[64:79]
  ds_read_b64_tr_b16 v[28:29], v5 offset:18496
  ds_read_b64_tr_b16 v[30:31], v5 offset:19264
  s_waitcnt lgkmcnt(10)
  v_mfma_f32_32x32x16_bf16 v[80:95], v[16:19], v[232:235], v[80:95]
  ds_read_b64_tr_b16 v[140:141], v6 offset:18496
  ds_read_b64_tr_b16 v[142:143], v6 offset:19264
  s_waitcnt lgkmcnt(10)
  v_mfma_f32_32x32x16_bf16 v[96:111], v[128:131], v[232:235], v[96:111]
  ds_read_b64_tr_b16 v[132:133], v5 offset:18560
  ds_read_b64_tr_b16 v[134:135], v5 offset:19328
  s_waitcnt lgkmcnt(10)
  v_mfma_f32_32x32x16_bf16 v[112:127], v[20:23], v[232:235], v[112:127]
  ds_read_b64_tr_b16 v[16:17], v6 offset:18560
  ds_read_b64_tr_b16 v[18:19], v6 offset:19328
  s_waitcnt lgkmcnt(10)
  v_mfma_f32_32x32x16_bf16 v[32:47], v[136:139], v[236:239], v[32:47]
  ds_read_b64_tr_b16 v[128:129], v5 offset:24576
  ds_read_b64_tr_b16 v[130:131], v5 offset:25344
  s_waitcnt lgkmcnt(10)
  v_mfma_f32_32x32x16_bf16 v[48:63], v[24:27], v[236:239], v[48:63]
  ds_read_b64_tr_b16 v[20:21], v5 offset:30720
  ds_read_b64_tr_b16 v[22:23], v5 offset:31488
  s_waitcnt lgkmcnt(10)
  v_mfma_f32_32x32x16_bf16 v[64:79], v[28:31], v[236:239], v[64:79]
  ds_read_b64_tr_b16 v[136:137], v5 offset:36864
  ds_read_b64_tr_b16 v[138:139], v5 offset:37632
  s_waitcnt lgkmcnt(10)
  v_mfma_f32_32x32x16_bf16 v[80:95], v[140:143], v[236:239], v[80:95]
  ds_read_b64_tr_b16 v[24:25], v5 offset:43008
  ds_read_b64_tr_b16 v[26:27], v5 offset:43776
  s_waitcnt lgkmcnt(10)
  v_mfma_f32_32x32x16_bf16 v[96:111], v[132:135], v[236:239], v[96:111]
  ds_read_b64_tr_b16 v[28:29], v6 offset:24576
  ds_read_b64_tr_b16 v[30:31], v6 offset:25344
  s_waitcnt lgkmcnt(10)
  v_mfma_f32_32x32x16_bf16 v[112:127], v[16:19], v[236:239], v[112:127]
  ds_read_b64_tr_b16 v[140:141], v6 offset:30720
  ds_read_b64_tr_b16 v[142:143], v6 offset:31488
  s_waitcnt lgkmcnt(10)
  v_mfma_f32_32x32x16_bf16 v[32:47], v[128:131], v[240:243], v[32:47]
  ds_read_b64_tr_b16 v[132:133], v6 offset:36864
  ds_read_b64_tr_b16 v[134:135], v6 offset:37632
  s_waitcnt lgkmcnt(10)
  v_mfma_f32_32x32x16_bf16 v[32:47], v[20:23], v[244:247], v[32:47]
  ds_read_b64_tr_b16 v[16:17], v6 offset:43008
  ds_read_b64_tr_b16 v[18:19], v6 offset:43776
  s_waitcnt lgkmcnt(10)
  v_mfma_f32_32x32x16_bf16 v[32:47], v[136:139], v[248:251], v[32:47]
  ds_read_b64_tr_b16 v[128:129], v5 offset:24640
  ds_read_b64_tr_b16 v[130:131], v5 offset:25408
  s_waitcnt lgkmcnt(10)
  v_mfma_f32_32x32x16_bf16 v[32:47], v[24:27], v[252:255], v[32:47]
  ds_read_b64_tr_b16 v[20:21], v5 offset:30784
  ds_read_b64_tr_b16 v[22:23], v5 offset:31552
  s_waitcnt lgkmcnt(10)
  v_mfma_f32_32x32x16_bf16 v[48:63], v[28:31], v[240:243], v[48:63]
  ds_read_b64_tr_b16 v[136:137], v5 offset:36928
  ds_read_b64_tr_b16 v[138:139], v5 offset:37696
  s_waitcnt lgkmcnt(10)
  v_mfma_f32_32x32x16_bf16 v[48:63], v[140:143], v[244:247], v[48:63]
  ds_read_b64_tr_b16 v[24:25], v5 offset:43072
  ds_read_b64_tr_b16 v[26:27], v5 offset:43840
  s_waitcnt lgkmcnt(10)
  v_mfma_f32_32x32x16_bf16 v[48:63], v[132:135], v[248:251], v[48:63]
  ds_read_b64_tr_b16 v[28:29], v6 offset:24640
  ds_read_b64_tr_b16 v[30:31], v6 offset:25408
  v_max_f32 v32, 0, v32
  v_max_f32 v33, 0, v33
  v_max_f32 v34, 0, v34
  v_max_f32 v35, 0, v35
  v_max_f32 v36, 0, v36
  s_waitcnt lgkmcnt(10)
  v_mfma_f32_32x32x16_bf16 v[48:63], v[16:19], v[252:255], v[48:63]
  ds_read_b64_tr_b16 v[140:141], v6 offset:30784
  ds_read_b64_tr_b16 v[142:143], v6 offset:31552
  v_max_f32 v37, 0, v37
  v_max_f32 v38, 0, v38
  v_max_f32 v39, 0, v39
  v_mul_f32 v32, v32, v40
  v_mul_f32 v33, v33, v41
  s_waitcnt lgkmcnt(10)
  v_mfma_f32_32x32x16_bf16 v[64:79], v[128:131], v[240:243], v[64:79]
  ds_read_b64_tr_b16 v[132:133], v6 offset:36928
  ds_read_b64_tr_b16 v[134:135], v6 offset:37696
  v_mul_f32 v34, v34, v42
  v_mul_f32 v35, v35, v43
  v_mul_f32 v36, v36, v44
  v_mul_f32 v37, v37, v45
  v_mul_f32 v38, v38, v46
  s_waitcnt lgkmcnt(10)
  v_mfma_f32_32x32x16_bf16 v[64:79], v[20:23], v[244:247], v[64:79]
  ds_read_b64_tr_b16 v[16:17], v6 offset:43072
  ds_read_b64_tr_b16 v[18:19], v6 offset:43840
  v_mul_f32 v39, v39, v47
  v_cvt_pk_bf16_f32 v32, v32, v33
  v_cvt_pk_bf16_f32 v33, v34, v35
  v_cvt_pk_bf16_f32 v34, v36, v37
  v_cvt_pk_bf16_f32 v35, v38, v39
  buffer_store_dwordx4 v[32:35], v1, s[52:55], s74 offen offset:0 sc1
  s_waitcnt lgkmcnt(10)
  v_mfma_f32_32x32x16_bf16 v[64:79], v[136:139], v[248:251], v[64:79]
  ds_read_b64_tr_b16 v[128:129], v5 offset:24704
  ds_read_b64_tr_b16 v[130:131], v5 offset:25472
  v_max_f32 v48, 0, v48
  v_max_f32 v49, 0, v49
  v_max_f32 v50, 0, v50
  v_max_f32 v51, 0, v51
  v_max_f32 v52, 0, v52
  s_waitcnt lgkmcnt(10)
  v_mfma_f32_32x32x16_bf16 v[64:79], v[24:27], v[252:255], v[64:79]
  ds_read_b64_tr_b16 v[20:21], v5 offset:30848
  ds_read_b64_tr_b16 v[22:23], v5 offset:31616
  v_max_f32 v53, 0, v53
  v_max_f32 v54, 0, v54
  v_max_f32 v55, 0, v55
  v_mul_f32 v48, v48, v56
  v_mul_f32 v49, v49, v57
  s_waitcnt lgkmcnt(10)
  v_mfma_f32_32x32x16_bf16 v[80:95], v[28:31], v[240:243], v[80:95]
  ds_read_b64_tr_b16 v[136:137], v5 offset:36992
  ds_read_b64_tr_b16 v[138:139], v5 offset:37760
  v_mul_f32 v50, v50, v58
  v_mul_f32 v51, v51, v59
  v_mul_f32 v52, v52, v60
  v_mul_f32 v53, v53, v61
  v_mul_f32 v54, v54, v62
  s_waitcnt lgkmcnt(10)
  v_mfma_f32_32x32x16_bf16 v[80:95], v[140:143], v[244:247], v[80:95]
  ds_read_b64_tr_b16 v[24:25], v5 offset:43136
  ds_read_b64_tr_b16 v[26:27], v5 offset:43904
  v_mul_f32 v55, v55, v63
  v_cvt_pk_bf16_f32 v48, v48, v49
  v_cvt_pk_bf16_f32 v49, v50, v51
  v_cvt_pk_bf16_f32 v50, v52, v53
  v_cvt_pk_bf16_f32 v51, v54, v55
  buffer_store_dwordx4 v[48:51], v1, s[52:55], s74 offen offset:1024 sc1
  s_waitcnt lgkmcnt(10)
  v_mfma_f32_32x32x16_bf16 v[80:95], v[132:135], v[248:251], v[80:95]
  ds_read_b64_tr_b16 v[28:29], v6 offset:24704
  ds_read_b64_tr_b16 v[30:31], v6 offset:25472
  v_max_f32 v64, 0, v64
  v_max_f32 v65, 0, v65
  v_max_f32 v66, 0, v66
  v_max_f32 v67, 0, v67
  v_max_f32 v68, 0, v68
  s_waitcnt lgkmcnt(10)
  v_mfma_f32_32x32x16_bf16 v[80:95], v[16:19], v[252:255], v[80:95]
  ds_read_b64_tr_b16 v[140:141], v6 offset:30848
  ds_read_b64_tr_b16 v[142:143], v6 offset:31616
  v_max_f32 v69, 0, v69
  v_max_f32 v70, 0, v70
  v_max_f32 v71, 0, v71
  v_mul_f32 v64, v64, v72
  v_mul_f32 v65, v65, v73
  s_waitcnt lgkmcnt(10)
  v_mfma_f32_32x32x16_bf16 v[96:111], v[128:131], v[240:243], v[96:111]
  ds_read_b64_tr_b16 v[132:133], v6 offset:36992
  ds_read_b64_tr_b16 v[134:135], v6 offset:37760
  v_mul_f32 v66, v66, v74
  v_mul_f32 v67, v67, v75
  v_mul_f32 v68, v68, v76
  v_mul_f32 v69, v69, v77
  v_mul_f32 v70, v70, v78
  s_waitcnt lgkmcnt(10)
  v_mfma_f32_32x32x16_bf16 v[96:111], v[20:23], v[244:247], v[96:111]
  ds_read_b64_tr_b16 v[16:17], v6 offset:43136
  ds_read_b64_tr_b16 v[18:19], v6 offset:43904
  v_mul_f32 v71, v71, v79
  v_cvt_pk_bf16_f32 v64, v64, v65
  v_cvt_pk_bf16_f32 v65, v66, v67
  v_cvt_pk_bf16_f32 v66, v68, v69
  v_cvt_pk_bf16_f32 v67, v70, v71
  buffer_store_dwordx4 v[64:67], v1, s[52:55], s74 offen offset:2048 sc1
  s_waitcnt lgkmcnt(10)
  v_mfma_f32_32x32x16_bf16 v[96:111], v[136:139], v[248:251], v[96:111]
  v_max_f32 v80, 0, v80
  v_max_f32 v81, 0, v81
  v_max_f32 v82, 0, v82
  v_max_f32 v83, 0, v83
  v_max_f32 v84, 0, v84
  s_waitcnt lgkmcnt(8)
  v_mfma_f32_32x32x16_bf16 v[96:111], v[24:27], v[252:255], v[96:111]
  v_max_f32 v85, 0, v85
  v_max_f32 v86, 0, v86
  v_max_f32 v87, 0, v87
  v_mul_f32 v80, v80, v88
  v_mul_f32 v81, v81, v89
  s_waitcnt lgkmcnt(6)
  v_mfma_f32_32x32x16_bf16 v[112:127], v[28:31], v[240:243], v[112:127]
  v_mul_f32 v82, v82, v90
  v_mul_f32 v83, v83, v91
  v_mul_f32 v84, v84, v92
  v_mul_f32 v85, v85, v93
  v_mul_f32 v86, v86, v94
  s_waitcnt lgkmcnt(4)
  v_mfma_f32_32x32x16_bf16 v[112:127], v[140:143], v[244:247], v[112:127]
  v_mul_f32 v87, v87, v95
  v_cvt_pk_bf16_f32 v80, v80, v81
  v_cvt_pk_bf16_f32 v81, v82, v83
  v_cvt_pk_bf16_f32 v82, v84, v85
  v_cvt_pk_bf16_f32 v83, v86, v87
  buffer_store_dwordx4 v[80:83], v1, s[52:55], s74 offen offset:3072 sc1
  s_waitcnt lgkmcnt(2)
  v_mfma_f32_32x32x16_bf16 v[112:127], v[132:135], v[248:251], v[112:127]
  v_max_f32 v96, 0, v96
  v_max_f32 v97, 0, v97
  v_max_f32 v98, 0, v98
  v_max_f32 v99, 0, v99
  v_max_f32 v100, 0, v100
  s_waitcnt lgkmcnt(0)
  v_mfma_f32_32x32x16_bf16 v[112:127], v[16:19], v[252:255], v[112:127]
  v_mov_b32 v10, 8196
  v_mov_b32 v11, 1
  s_mov_b64 exec, 1
  ds_add_u32 v10, v11
  s_mov_b64 exec, -1
  v_max_f32 v101, 0, v101
  v_max_f32 v102, 0, v102
  v_max_f32 v103, 0, v103
  v_mul_f32 v96, v96, v104
  v_mul_f32 v97, v97, v105
  v_mul_f32 v98, v98, v106
  v_mul_f32 v99, v99, v107
  v_mul_f32 v100, v100, v108
  v_mul_f32 v101, v101, v109
  v_mul_f32 v102, v102, v110
  v_mul_f32 v103, v103, v111
  v_cvt_pk_bf16_f32 v96, v96, v97
  v_cvt_pk_bf16_f32 v97, v98, v99
  v_cvt_pk_bf16_f32 v98, v100, v101
  v_cvt_pk_bf16_f32 v99, v102, v103
  buffer_store_dwordx4 v[96:99], v1, s[52:55], s75 offen offset:0 sc1
  v_max_f32 v112, 0, v112
  v_max_f32 v113, 0, v113
  v_max_f32 v114, 0, v114
  v_max_f32 v115, 0, v115
  v_max_f32 v116, 0, v116
  v_max_f32 v117, 0, v117
  v_max_f32 v118, 0, v118
  v_max_f32 v119, 0, v119
  v_mul_f32 v112, v112, v120
  v_mul_f32 v113, v113, v121
  v_mul_f32 v114, v114, v122
  v_mul_f32 v115, v115, v123
  v_mul_f32 v116, v116, v124
  v_mul_f32 v117, v117, v125
  v_mul_f32 v118, v118, v126
  v_mul_f32 v119, v119, v127
  v_cvt_pk_bf16_f32 v112, v112, v113
  v_cvt_pk_bf16_f32 v113, v114, v115
  v_cvt_pk_bf16_f32 v114, v116, v117
  v_cvt_pk_bf16_f32 v115, v118, v119
  buffer_store_dwordx4 v[112:115], v1, s[52:55], s75 offen offset:1024 sc1
  s_setprio 1
  v_and_b32 v29, 31, v0
  v_lshrrev_b32 v30, 5, v0
  v_and_b32 v2, 0x33, v0
  v_bfe_u32 v6, v0, 2, 1
  v_lshl_add_u32 v2, v6, 3, v2
  v_bfe_u32 v6, v0, 3, 1
  v_lshl_add_u32 v2, v6, 2, v2
  v_lshlrev_b32 v2, 4, v2
  v_add_u32 v2, 8448, v2
  v_lshl_add_u32 v6, v30, 4, v29
  v_lshlrev_b32 v6, 4, v6
  v_add_u32 v3, 9472, v6
  v_add_u32 v4, 9984, v6
  v_add_u32 v6, 4, v29
  v_and_b32 v6, 24, v6
  v_mov_b32 v7, 10512
  v_mov_b32 v5, 14672
  v_cmp_eq_u32 vcc, 24, v6
  s_nop 1
  v_cndmask_b32 v7, v7, v5, vcc
  v_and_b32 v6, 27, v29
  v_cmp_eq_u32 vcc, 16, v6
  v_subrev_u32 v5, 16, v7
  s_nop 0
  v_cndmask_b32 v7, v7, v5, vcc
  v_cmp_le_u32 vcc, 16, v29
  s_nop 1
  v_cndmask_b32 v3, v3, v7, vcc
  v_cndmask_b32 v4, v4, v7, vcc
  v_mov_b32 v5, 0xdddddddd
  v_mov_b32 v80, 0
  v_mov_b32 v81, 0
  v_mov_b32 v82, 0
  v_mov_b32 v83, 0
  v_mov_b32 v84, 0
  v_mov_b32 v85, 0
  v_mov_b32 v86, 0
  v_mov_b32 v87, 0
  v_mov_b32 v88, 0
  v_mov_b32 v89, 0
  v_mov_b32 v90, 0
  v_mov_b32 v91, 0
  v_mov_b32 v92, 0
  v_mov_b32 v93, 0
  v_mov_b32 v94, 0
  v_mov_b32 v95, 0
  v_mov_b32 v56, 0
  v_mov_b32 v57, 0
  v_mov_b32 v58, 0
  v_mov_b32 v59, 0
  v_mov_b32 v60, 0
  v_mov_b32 v61, 0
  v_mov_b32 v62, 0
  v_mov_b32 v63, 0
  v_mov_b32 v20, 0
  v_mov_b32 v21, 0
  v_mov_b32 v22, 0
  v_mov_b32 v23, 0
  s_and_b32 s62, s56, 1
  s_lshr_b32 s63, s56, 1
  s_mul_i32 s64, s63, 22
  s_add_u32 s65, s63, 1
  s_lshr_b32 s65, s65, 2
  s_sub_u32 s64, s64, s65
  s_lshl1_add_u32 s62, s9, s62
  s_mul_i32 s62, s62, 236
  s_add_u32 s62, s62, s64
  s_lshl_b32 s62, s62, 10
  s_add_u32 s10, s62, 11927552
  s_add_u32 s11, s10, 120832
  s_mul_i32 s62, s8, 86
  s_add_u32 s62, s62, s64
  s_lshl_b32 s62, s62, 10
  s_add_u32 s12, s62, 6291456
  s_and_b32 s62, s56, 3
  s_lshl2_add_u32 s62, s9, s62
  s_mul_i32 s62, s62, 118
  s_lshr_b32 s63, s56, 2
  s_lshl4_add_u32 s62, s63, s62
  s_add_u32 s62, s62, 86
  s_lshl_b32 s62, s62, 10
  s_add_u32 s13, s62, 11927552
  s_lshl3_add_u32 s62, s7, s56
  s_lshl_b32 s62, s62, 5
  s_add_u32 s62, s62, s6
  s_lshl_b32 s62, s62, 10
  s_add_u32 s14, s62, 13893632
  s_lshl3_add_u32 s62, s8, s56
  s_lshl_b32 s62, s62, 12
  s_add_u32 s15, s62, 13893632
  s_lshl3_add_u32 s62, s8, s56
  s_lshl_b32 s62, s62, 12
  s_lshl_b32 s63, s9, 8
  s_add_u32 s16, s62, s63
  v_lshrrev_b32 v6, 4, v0
  v_and_b32 v7, 15, v0
  v_lshlrev_b32 v28, 10, v6
  v_lshl_add_u32 v28, v7, 4, v28
  s_and_b32 s62, s56, 1
  s_lshl1_add_u32 s62, s9, s62
  s_mul_i32 s62, s62, 236
  s_lshr_b32 s63, s56, 1
  s_lshl3_add_u32 s62, s63, s62
  s_add_u32 s62, s62, 86
  s_lshl_b32 s62, s62, 10
  s_add_u32 s13, s62, 11927552
  s_lshl2_add_u32 s62, s8, s63
  s_lshl_b32 s62, s62, 13
  s_add_u32 s15, s62, 13893632
  s_add_u32 s66, s15, 4096
  v_lshlrev_b32 v31, 3, v7
  s_lshl_b32 s62, s8, 7
  s_add_u32 s3, s62, 16257024
  s_lshl2_add_u32 s62, s59, s56
  s_lshl4_add_u32 s62, s62, s60
  s_lshl3_add_u32 s19, s62, 16257024
  s_cmp_lt_u32 s56, 4
  s_cselect_b32 s21, 7, 0
  s_cselect_b32 s22, 0, 7
  s_cselect_b32 s23, 7, 1
  v_mov_b32 v96, 0
  v_mov_b32 v97, 0
  v_mov_b32 v98, 0
  v_mov_b32 v99, 0
  v_mov_b32 v100, 0
  v_mov_b32 v101, 0
  v_mov_b32 v102, 0
  v_mov_b32 v103, 0
  v_mov_b32 v104, 0
  v_mov_b32 v105, 0
  v_mov_b32 v106, 0
  v_mov_b32 v107, 0
  v_mov_b32 v108, 0
  v_mov_b32 v109, 0
  v_mov_b32 v110, 0
  v_mov_b32 v111, 0
  v_mov_b32 v112, 0
  v_mov_b32 v113, 0
  v_mov_b32 v114, 0
  v_mov_b32 v115, 0
  v_mov_b32 v116, 0
  v_mov_b32 v117, 0
  v_mov_b32 v118, 0
  v_mov_b32 v119, 0
  v_mov_b32 v120, 0
  v_mov_b32 v121, 0
  v_mov_b32 v122, 0
  v_mov_b32 v123, 0
  v_mov_b32 v124, 0
  v_mov_b32 v125, 0
  v_mov_b32 v126, 0
  v_mov_b32 v127, 0
L_att:
  v_mov_b32 v6, 8192
  s_mov_b32 s62, 0
L_wA:
  ds_read_b32 v7, v6
  s_add_u32 s62, s62, 1
  s_cmp_ge_u32 s62, 4194304
  s_cbranch_scc1 L_wA_x
  s_waitcnt lgkmcnt(0)
  v_cmp_gt_u32 vcc, 4, v7
  s_cbranch_vccnz L_wA
L_wA_x:
  s_lshl3_add_u32 s62, s2, s56
  s_cmp_eq_u32 s62, 4
  s_cbranch_scc0 L_notag
  v_mov_b32 v130, 0
  v_mov_b32 v128, s100
  v_mov_b32 v129, s101
  s_mov_b32 s62, 16252928
  buffer_store_dwordx2 v[128:129], v130, s[52:55], s62 offen sc1
L_notag:
  s_lshl_b32 s62, s56, 10
  v_add_u32 v6, s62, v1
  ds_read_b128 v[8:11], v6
  ds_read_b128 v[24:27], v2
  ds_read_b128 v[12:15], v2 offset:2080
  ds_read_b128 v[16:19], v3
  s_waitcnt lgkmcnt(2)
  v_mfma_f32_32x32x16_bf16 v[32:47], v[24:27], v[8:11], 0
  s_nop 11
  v_max3_f32 v6, v32, v33, v34
  v_max3_f32 v6, v6, v35, v36
  v_max3_f32 v6, v6, v37, v38
  v_max3_f32 v6, v6, v39, v40
  v_max3_f32 v6, v6, v41, v42
  v_max3_f32 v6, v6, v43, v44
  v_max3_f32 v6, v6, v45, v46
  v_max_f32 v6, v6, v47
  v_mov_b32 v7, v6
  s_nop 1
  v_permlane32_swap_b32 v6, v7
  v_max_f32 v6, v6, v7
  v_sub_f32 v64, 0, v6
  v_sub_f32 v65, 0, v6
  v_sub_f32 v66, 0, v6
  v_sub_f32 v67, 0, v6
  v_sub_f32 v68, 0, v6
  v_sub_f32 v69, 0, v6
  v_sub_f32 v70, 0, v6
  v_sub_f32 v71, 0, v6
  v_sub_f32 v72, 0, v6
  v_sub_f32 v73, 0, v6
  v_sub_f32 v74, 0, v6
  v_sub_f32 v75, 0, v6
  v_sub_f32 v76, 0, v6
  v_sub_f32 v77, 0, v6
  v_sub_f32 v78, 0, v6
  v_sub_f32 v79, 0, v6
  v_sub_f32 v32, v32, v6
  v_sub_f32 v33, v33, v6
  v_sub_f32 v34, v34, v6
  v_sub_f32 v35, v35, v6
  v_sub_f32 v36, v36, v6
  v_sub_f32 v37, v37, v6
  v_sub_f32 v38, v38, v6
  v_sub_f32 v39, v39, v6
  v_sub_f32 v40, v40, v6
  v_sub_f32 v41, v41, v6
  v_sub_f32 v42, v42, v6
  v_sub_f32 v43, v43, v6
  v_sub_f32 v44, v44, v6
  v_sub_f32 v45, v45, v6
  v_sub_f32 v46, v46, v6
  v_sub_f32 v47, v47, v6
  s_mov_b32 s20, 0
L_attA:
  v_exp_f32 v32, v32
  v_exp_f32 v33, v33
  s_waitcnt lgkmcnt(0)
  v_smfmac_f32_32x32x32_bf16 v[80:95], v[20:23], v[56:63], v5
  ds_read_b128 v[20:23], v4 offset:0
  ds_read_b128 v[240:243], v3 offset:2080
  v_exp_f32 v34, v34
  v_exp_f32 v35, v35
  v_exp_f32 v36, v36
  v_mfma_f32_32x32x16_bf16 v[48:63], v[12:15], v[8:11], v[64:79]
  ds_read_b128 v[12:15], v2 offset:4160
  v_exp_f32 v37, v37
  v_exp_f32 v38, v38
  v_exp_f32 v39, v39
  v_exp_f32 v40, v40
  v_exp_f32 v41, v41
  v_smfmac_f32_32x32x32_bf16 v[80:95], v[16:19], v[32:39], v5
  s_cmp_lg_u32 s20, s21
  s_cbranch_scc1 L_attA_d0
  v_mov_b32 v6, 8196
  s_mov_b32 s62, 0
L_wB:
  ds_read_b32 v7, v6
  s_add_u32 s62, s62, 1
  s_cmp_ge_u32 s62, 4194304
  s_cbranch_scc1 L_wB_x
  s_waitcnt lgkmcnt(0)
  v_cmp_gt_u32 vcc, 4, v7
  s_cbranch_vccnz L_wB
L_wB_x:
  v_min_u32 v6, 46, v0
  v_mul_u32_u24 v6, 2080, v6
  ds_write_b128 v6, v[244:247] offset:50016
  ds_write_b128 v6, v[248:251] offset:50032
  s_add_u32 m0, s18, 33280
  s_add_u32 s62, s17, 49152
  buffer_load_dwordx4 v1, s[52:55], s62 offen sc1 lds
  buffer_load_dwordx4 v1, s[52:55], s62 offen offset:1024 sc1 lds
  s_add_u32 m0, s18, 35360
  s_add_u32 s62, s17, 52224
  buffer_load_dwordx4 v1, s[52:55], s62 offen sc1 lds
  buffer_load_dwordx4 v1, s[52:55], s62 offen offset:1024 sc1 lds
L_attA_d0:
  v_exp_f32 v42, v42
  v_exp_f32 v43, v43
  v_exp_f32 v44, v44
  v_exp_f32 v45, v45
  v_exp_f32 v46, v46
  v_exp_f32 v47, v47
  v_exp_f32 v48, v48
  v_exp_f32 v49, v49
  s_waitcnt lgkmcnt(0)
  v_smfmac_f32_32x32x32_bf16 v[80:95], v[20:23], v[40:47], v5
  ds_read_b128 v[20:23], v4 offset:2080
  ds_read_b128 v[16:19], v3 offset:4160
  v_exp_f32 v50, v50
  v_exp_f32 v51, v51
  v_exp_f32 v52, v52
  v_mfma_f32_32x32x16_bf16 v[32:47], v[12:15], v[8:11], v[64:79]
  ds_read_b128 v[12:15], v2 offset:6240
  v_exp_f32 v53, v53
  v_exp_f32 v54, v54
  v_exp_f32 v55, v55
  v_exp_f32 v56, v56
  v_exp_f32 v57, v57
  v_smfmac_f32_32x32x32_bf16 v[80:95], v[240:243], v[48:55], v5
  s_cmp_lg_u32 s20, s21
  s_cbranch_scc1 L_attA_d1
  s_add_u32 m0, s18, 37440
  s_add_u32 s62, s17, 55296
  buffer_load_dwordx4 v1, s[52:55], s62 offen sc1 lds
  buffer_load_dwordx4 v1, s[52:55], s62 offen offset:1024 sc1 lds
  s_add_u32 m0, s18, 39520
  s_add_u32 s62, s17, 58368
  buffer_load_dwordx4 v1, s[52:55], s62 offen sc1 lds
  buffer_load_dwordx4 v1, s[52:55], s62 offen offset:1024 sc1 lds
L_attA_d1:
  v_exp_f32 v58, v58
  v_exp_f32 v59, v59
  v_exp_f32 v60, v60
  v_exp_f32 v61, v61
  v_exp_f32 v62, v62
  v_exp_f32 v63, v63
  v_exp_f32 v32, v32
  v_exp_f32 v33, v33
  s_waitcnt lgkmcnt(0)
  v_smfmac_f32_32x32x32_bf16 v[80:95], v[20:23], v[56:63], v5
  ds_read_b128 v[20:23], v4 offset:4160
  ds_read_b128 v[240:243], v3 offset:6240
  v_exp_f32 v34, v34
  v_exp_f32 v35, v35
  v_exp_f32 v36, v36
  v_mfma_f32_32x32x16_bf16 v[48:63], v[12:15], v[8:11], v[64:79]
  ds_read_b128 v[12:15], v2 offset:8320
  v_exp_f32 v37, v37
  v_exp_f32 v38, v38
  v_exp_f32 v39, v39
  v_exp_f32 v40, v40
  v_exp_f32 v41, v41
  v_smfmac_f32_32x32x32_bf16 v[80:95], v[16:19], v[32:39], v5
  s_cmp_lg_u32 s20, s21
  s_cbranch_scc1 L_attA_d2
  s_add_u32 m0, s18, 66560
  s_add_u32 s62, s17, 98304
  buffer_load_dwordx4 v1, s[52:55], s62 offen sc1 lds
  buffer_load_dwordx4 v1, s[52:55], s62 offen offset:1024 sc1 lds
  s_add_u32 m0, s18, 68640
  s_add_u32 s62, s17, 101376
  buffer_load_dwordx4 v1, s[52:55], s62 offen sc1 lds
  buffer_load_dwordx4 v1, s[52:55], s62 offen offset:1024 sc1 lds
L_attA_d2:
  v_exp_f32 v42, v42
  v_exp_f32 v43, v43
  v_exp_f32 v44, v44
  s_cmp_lg_u32 s20, s23
  s_cbranch_scc1 L_attA_ns
  s_waitcnt vmcnt(0)
  v_mov_b32 v6, 8200
  v_mov_b32 v7, 1
  s_mov_b64 exec, 1
  ds_add_u32 v6, v7
  s_mov_b64 exec, -1
L_attA_ns:
  v_exp_f32 v45, v45
  v_exp_f32 v46, v46
  v_exp_f32 v47, v47
  v_exp_f32 v48, v48
  v_exp_f32 v49, v49
  s_waitcnt lgkmcnt(0)
  v_smfmac_f32_32x32x32_bf16 v[80:95], v[20:23], v[40:47], v5
  ds_read_b128 v[20:23], v4 offset:6240
  ds_read_b128 v[16:19], v3 offset:8320
  v_exp_f32 v50, v50
  v_exp_f32 v51, v51
  v_exp_f32 v52, v52
  v_mfma_f32_32x32x16_bf16 v[32:47], v[12:15], v[8:11], v[64:79]
  ds_read_b128 v[12:15], v2 offset:10400
  v_exp_f32 v53, v53
  v_exp_f32 v54, v54
  v_exp_f32 v55, v55
  v_exp_f32 v56, v56
  v_exp_f32 v57, v57
  v_smfmac_f32_32x32x32_bf16 v[80:95], v[240:243], v[48:55], v5
  s_cmp_lg_u32 s20, s21
  s_cbranch_scc1 L_attA_d3
  s_add_u32 m0, s18, 70720
  s_add_u32 s62, s17, 104448
  buffer_load_dwordx4 v1, s[52:55], s62 offen sc1 lds
  buffer_load_dwordx4 v1, s[52:55], s62 offen offset:1024 sc1 lds
  s_add_u32 m0, s18, 72800
  s_add_u32 s62, s17, 107520
  buffer_load_dwordx4 v1, s[52:55], s62 offen sc1 lds
  buffer_load_dwordx4 v1, s[52:55], s62 offen offset:1024 sc1 lds
L_attA_d3:
  v_exp_f32 v58, v58
  v_exp_f32 v59, v59
  v_exp_f32 v60, v60
  s_cmp_lg_u32 s20, s22
  s_cbranch_scc1 L_attA_nf
  v_mov_b32 v6, s100
  v_mov_b32 v7, s101
  v_mov_b32 v30, 0
  s_waitcnt vmcnt(0)
  buffer_store_dwordx2 v[6:7], v30, s[52:55], s19 offen sc1
L_attA_nf:
  v_exp_f32 v61, v61
  v_exp_f32 v62, v62
  v_exp_f32 v63, v63
  v_exp_f32 v32, v32
  v_exp_f32 v33, v33
  s_waitcnt lgkmcnt(0)
  v_smfmac_f32_32x32x32_bf16 v[80:95], v[20:23], v[56:63], v5
  ds_read_b128 v[20:23], v4 offset:8320
  ds_read_b128 v[240:243], v3 offset:10400
  v_exp_f32 v34, v34
  v_exp_f32 v35, v35
  v_exp_f32 v36, v36
  v_mfma_f32_32x32x16_bf16 v[48:63], v[12:15], v[8:11], v[64:79]
  ds_read_b128 v[12:15], v2 offset:12480
  v_exp_f32 v37, v37
  v_exp_f32 v38, v38
  v_exp_f32 v39, v39
  v_exp_f32 v40, v40
  v_exp_f32 v41, v41
  v_smfmac_f32_32x32x32_bf16 v[80:95], v[16:19], v[32:39], v5
  s_cmp_lg_u32 s20, s21
  s_cbranch_scc1 L_attA_d4
  s_add_u32 m0, s18, 99840
  s_add_u32 s62, s17, 147456
  buffer_load_dwordx4 v1, s[52:55], s62 offen sc1 lds
  buffer_load_dwordx4 v1, s[52:55], s62 offen offset:1024 sc1 lds
  s_add_u32 m0, s18, 101920
  s_add_u32 s62, s17, 150528
  buffer_load_dwordx4 v1, s[52:55], s62 offen sc1 lds
  buffer_load_dwordx4 v1, s[52:55], s62 offen offset:1024 sc1 lds
L_attA_d4:
  v_exp_f32 v42, v42
  v_exp_f32 v43, v43
  v_exp_f32 v44, v44
  v_exp_f32 v45, v45
  v_exp_f32 v46, v46
  v_exp_f32 v47, v47
  v_exp_f32 v48, v48
  v_exp_f32 v49, v49
  s_waitcnt lgkmcnt(0)
  v_smfmac_f32_32x32x32_bf16 v[80:95], v[20:23], v[40:47], v5
  ds_read_b128 v[20:23], v4 offset:10400
  ds_read_b128 v[16:19], v3 offset:12480
  v_exp_f32 v50, v50
  v_exp_f32 v51, v51
  v_exp_f32 v52, v52
  v_mfma_f32_32x32x16_bf16 v[32:47], v[12:15], v[8:11], v[64:79]
  ds_read_b128 v[12:15], v2 offset:14560
  v_exp_f32 v53, v53
  v_exp_f32 v54, v54
  v_exp_f32 v55, v55
  v_exp_f32 v56, v56
  v_exp_f32 v57, v57
  v_smfmac_f32_32x32x32_bf16 v[80:95], v[240:243], v[48:55], v5
  s_cmp_lg_u32 s20, s21
  s_cbranch_scc1 L_attA_d5
  s_add_u32 m0, s18, 104000
  s_add_u32 s62, s17, 153600
  buffer_load_dwordx4 v1, s[52:55], s62 offen sc1 lds
  buffer_load_dwordx4 v1, s[52:55], s62 offen offset:1024 sc1 lds
  s_add_u32 m0, s18, 106080
  s_add_u32 s62, s17, 156672
  buffer_load_dwordx4 v1, s[52:55], s62 offen sc1 lds
  buffer_load_dwordx4 v1, s[52:55], s62 offen offset:1024 sc1 lds
L_attA_d5:
  v_exp_f32 v58, v58
  v_exp_f32 v59, v59
  v_exp_f32 v60, v60
  s_cmp_lg_u32 s20, 1
  s_cbranch_scc1 L_attA_nw
  v_mov_b32 v6, 8200
  s_mov_b32 s62, 0
L_wC:
  ds_read_b32 v7, v6
  s_add_u32 s62, s62, 1
  s_cmp_ge_u32 s62, 4194304
  s_cbranch_scc1 L_wC_x
  s_waitcnt lgkmcnt(0)
  v_cmp_gt_u32 vcc, 4, v7
  s_cbranch_vccnz L_wC
L_wC_x:
L_attA_nw:
  v_exp_f32 v61, v61
  v_exp_f32 v62, v62
  v_exp_f32 v63, v63
  v_exp_f32 v32, v32
  v_exp_f32 v33, v33
  s_waitcnt lgkmcnt(0)
  v_smfmac_f32_32x32x32_bf16 v[80:95], v[20:23], v[56:63], v5
  ds_read_b128 v[20:23], v4 offset:12480
  ds_read_b128 v[240:243], v3 offset:14560
  v_exp_f32 v34, v34
  v_exp_f32 v35, v35
  v_exp_f32 v36, v36
  v_mfma_f32_32x32x16_bf16 v[48:63], v[12:15], v[8:11], v[64:79]
  ds_read_b128 v[12:15], v2 offset:16640
  v_exp_f32 v37, v37
  v_exp_f32 v38, v38
  v_exp_f32 v39, v39
  v_exp_f32 v40, v40
  v_exp_f32 v41, v41
  v_smfmac_f32_32x32x32_bf16 v[80:95], v[16:19], v[32:39], v5
  v_exp_f32 v42, v42
  v_exp_f32 v43, v43
  v_exp_f32 v44, v44
  v_exp_f32 v45, v45
  v_exp_f32 v46, v46
  v_exp_f32 v47, v47
  v_exp_f32 v48, v48
  v_exp_f32 v49, v49
  s_waitcnt lgkmcnt(0)
  v_smfmac_f32_32x32x32_bf16 v[80:95], v[20:23], v[40:47], v5
  ds_read_b128 v[20:23], v4 offset:14560
  ds_read_b128 v[16:19], v3 offset:16640
  v_exp_f32 v50, v50
  v_exp_f32 v51, v51
  v_exp_f32 v52, v52
  v_mfma_f32_32x32x16_bf16 v[32:47], v[12:15], v[8:11], v[64:79]
  ds_read_b128 v[12:15], v2 offset:18720
  v_exp_f32 v53, v53
  v_exp_f32 v54, v54
  v_exp_f32 v55, v55
  v_exp_f32 v56, v56
  v_exp_f32 v57, v57
  v_smfmac_f32_32x32x32_bf16 v[80:95], v[240:243], v[48:55], v5
  v_exp_f32 v58, v58
  v_exp_f32 v59, v59
  v_exp_f32 v60, v60
  v_exp_f32 v61, v61
  v_exp_f32 v62, v62
  v_exp_f32 v63, v63
  v_add_u32 v2, 16640, v2
  v_add_u32 v3, 16640, v3
  v_add_u32 v4, 16640, v4
  s_add_u32 s20, s20, 1
  s_cmp_lt_u32 s20, 2
  s_cbranch_scc1 L_attA
  v_exp_f32 v32, v32
  v_exp_f32 v33, v33
  s_waitcnt lgkmcnt(0)
  v_smfmac_f32_32x32x32_bf16 v[80:95], v[20:23], v[56:63], v5
  ds_read_b128 v[20:23], v4 offset:0
  ds_read_b128 v[240:243], v3 offset:2080
  buffer_load_dwordx4 v[176:179], v1, s[52:55], s13 offen offset:0 sc1
  buffer_load_dwordx4 v[180:183], v1, s[52:55], s13 offen offset:1024 sc1
  v_exp_f32 v34, v34
  v_exp_f32 v35, v35
  v_exp_f32 v36, v36
  v_mfma_f32_32x32x16_bf16 v[48:63], v[12:15], v[8:11], v[64:79]
  ds_read_b128 v[12:15], v2 offset:4160
  v_exp_f32 v37, v37
  v_exp_f32 v38, v38
  v_exp_f32 v39, v39
  v_exp_f32 v40, v40
  v_exp_f32 v41, v41
  v_smfmac_f32_32x32x32_bf16 v[80:95], v[16:19], v[32:39], v5
  buffer_load_dwordx4 v[184:187], v1, s[52:55], s13 offen offset:2048 sc1
  buffer_load_dwordx4 v[188:191], v1, s[52:55], s13 offen offset:3072 sc1
  s_add_u32 s13, s13, 4096
  v_exp_f32 v42, v42
  v_exp_f32 v43, v43
  v_exp_f32 v44, v44
  buffer_load_dwordx4 v[24:27], v28, s[24:27], s16 offen
  v_exp_f32 v45, v45
  v_exp_f32 v46, v46
  v_exp_f32 v47, v47
  v_exp_f32 v48, v48
  v_exp_f32 v49, v49
  s_waitcnt lgkmcnt(0)
  v_smfmac_f32_32x32x32_bf16 v[80:95], v[20:23], v[40:47], v5
  ds_read_b128 v[20:23], v4 offset:2080
  ds_read_b128 v[16:19], v3 offset:4160
  buffer_load_dwordx4 v[192:195], v1, s[52:55], s13 offen offset:0 sc1
  buffer_load_dwordx4 v[196:199], v1, s[52:55], s13 offen offset:1024 sc1
  v_exp_f32 v50, v50
  v_exp_f32 v51, v51
  v_exp_f32 v52, v52
  v_mfma_f32_32x32x16_bf16 v[32:47], v[12:15], v[8:11], v[64:79]
  ds_read_b128 v[12:15], v2 offset:6240
  v_exp_f32 v53, v53
  v_exp_f32 v54, v54
  v_exp_f32 v55, v55
  v_exp_f32 v56, v56
  v_exp_f32 v57, v57
  v_smfmac_f32_32x32x32_bf16 v[80:95], v[240:243], v[48:55], v5
  buffer_load_dwordx4 v[200:203], v1, s[52:55], s13 offen offset:2048 sc1
  buffer_load_dwordx4 v[204:207], v1, s[52:55], s13 offen offset:3072 sc1
  s_add_u32 s13, s13, 116736
  v_exp_f32 v58, v58
  v_exp_f32 v59, v59
  v_exp_f32 v60, v60
  v_exp_f32 v61, v61
  v_exp_f32 v62, v62
  v_exp_f32 v63, v63
  v_exp_f32 v32, v32
  v_exp_f32 v33, v33
  s_waitcnt lgkmcnt(0)
  v_smfmac_f32_32x32x32_bf16 v[80:95], v[20:23], v[56:63], v5
  ds_read_b128 v[20:23], v4 offset:4160
  ds_read_b128 v[240:243], v3 offset:6240
  buffer_load_dwordx2 v[6:7], v31, s[52:55], s3 offen sc1
  buffer_load_dwordx4 v[208:211], v1, s[52:55], s13 offen offset:0 sc1
  buffer_load_dwordx4 v[212:215], v1, s[52:55], s13 offen offset:1024 sc1
  v_exp_f32 v34, v34
  v_exp_f32 v35, v35
  v_exp_f32 v36, v36
  v_mfma_f32_32x32x16_bf16 v[48:63], v[12:15], v[8:11], v[64:79]
  ds_read_b128 v[12:15], v2 offset:8320
  v_exp_f32 v37, v37
  v_exp_f32 v38, v38
  v_exp_f32 v39, v39
  v_exp_f32 v40, v40
  v_exp_f32 v41, v41
  v_smfmac_f32_32x32x32_bf16 v[80:95], v[16:19], v[32:39], v5
  buffer_load_dwordx4 v[216:219], v1, s[52:55], s13 offen offset:2048 sc1
  buffer_load_dwordx4 v[220:223], v1, s[52:55], s13 offen offset:3072 sc1
  s_add_u32 s13, s13, 4096
  v_exp_f32 v42, v42
  v_exp_f32 v43, v43
  v_exp_f32 v44, v44
  v_exp_f32 v45, v45
  v_exp_f32 v46, v46
  v_exp_f32 v47, v47
  v_exp_f32 v48, v48
  v_exp_f32 v49, v49
  s_waitcnt lgkmcnt(0)
  v_smfmac_f32_32x32x32_bf16 v[80:95], v[20:23], v[40:47], v5
  ds_read_b128 v[20:23], v4 offset:6240
  ds_read_b128 v[16:19], v3 offset:8320
  buffer_load_dwordx4 v[224:227], v1, s[52:55], s13 offen offset:0 sc1
  buffer_load_dwordx4 v[228:231], v1, s[52:55], s13 offen offset:1024 sc1
  v_exp_f32 v50, v50
  v_exp_f32 v51, v51
  v_exp_f32 v52, v52
  v_mfma_f32_32x32x16_bf16 v[32:47], v[12:15], v[8:11], v[64:79]
  ds_read_b128 v[12:15], v2 offset:10400
  v_exp_f32 v53, v53
  v_exp_f32 v54, v54
  v_exp_f32 v55, v55
  v_exp_f32 v56, v56
  v_exp_f32 v57, v57
  v_smfmac_f32_32x32x32_bf16 v[80:95], v[240:243], v[48:55], v5
  buffer_load_dwordx4 v[232:235], v1, s[52:55], s13 offen offset:2048 sc1
  buffer_load_dwordx4 v[236:239], v1, s[52:55], s13 offen offset:3072 sc1
  s_add_u32 s13, s13, 4096
  v_exp_f32 v58, v58
  v_exp_f32 v59, v59
  v_exp_f32 v60, v60
  v_exp_f32 v61, v61
  v_exp_f32 v62, v62
  v_exp_f32 v63, v63
  v_exp_f32 v32, v32
  v_exp_f32 v33, v33
  s_waitcnt lgkmcnt(0)
  v_smfmac_f32_32x32x32_bf16 v[80:95], v[20:23], v[56:63], v5
  ds_read_b128 v[20:23], v4 offset:8320
  ds_read_b128 v[240:243], v3 offset:10400
  buffer_load_dwordx4 v[128:131], v1, s[52:55], s10 offen offset:0 sc1
  v_exp_f32 v34, v34
  v_exp_f32 v35, v35
  v_exp_f32 v36, v36
  v_mfma_f32_32x32x16_bf16 v[48:63], v[12:15], v[8:11], v[64:79]
  ds_read_b128 v[12:15], v2 offset:12480
  v_exp_f32 v37, v37
  v_exp_f32 v38, v38
  v_exp_f32 v39, v39
  v_exp_f32 v40, v40
  v_exp_f32 v41, v41
  v_smfmac_f32_32x32x32_bf16 v[80:95], v[16:19], v[32:39], v5
  buffer_load_dwordx4 v[132:135], v1, s[52:55], s11 offen offset:0 sc1
  s_waitcnt vmcnt(10)
  v_cmp_ne_u64 vcc, s[100:101], v[6:7]
  s_cbranch_vccnz L_f2slow
L_f2ok:
  buffer_load_dwordx4 v[136:139], v1, s[52:55], s12 offen offset:0 sc1
  v_exp_f32 v42, v42
  v_exp_f32 v43, v43
  v_exp_f32 v44, v44
  v_exp_f32 v45, v45
  v_exp_f32 v46, v46
  v_exp_f32 v47, v47
  v_exp_f32 v48, v48
  v_exp_f32 v49, v49
  s_waitcnt lgkmcnt(0)
  v_smfmac_f32_32x32x32_bf16 v[80:95], v[20:23], v[40:47], v5
  ds_read_b128 v[20:23], v4 offset:10400
  ds_read_b128 v[16:19], v3 offset:12480
  buffer_load_dwordx4 v[140:143], v1, s[52:55], s10 offen offset:1024 sc1
  v_exp_f32 v50, v50
  v_exp_f32 v51, v51
  v_exp_f32 v52, v52
  v_mfma_f32_32x32x16_bf16 v[32:47], v[12:15], v[8:11], v[64:79]
  ds_read_b128 v[12:15], v2 offset:14560
  v_exp_f32 v53, v53
  v_exp_f32 v54, v54
  v_exp_f32 v55, v55
  v_exp_f32 v56, v56
  v_exp_f32 v57, v57
  v_smfmac_f32_32x32x32_bf16 v[80:95], v[240:243], v[48:55], v5
  buffer_load_dwordx4 v[144:147], v1, s[52:55], s11 offen offset:1024 sc1
  buffer_load_dwordx4 v[148:151], v1, s[52:55], s12 offen offset:1024 sc1
  v_exp_f32 v58, v58
  v_exp_f32 v59, v59
  v_exp_f32 v60, v60
  v_exp_f32 v61, v61
  v_exp_f32 v62, v62
  v_exp_f32 v63, v63
  v_exp_f32 v32, v32
  v_exp_f32 v33, v33
  s_waitcnt lgkmcnt(0)
  v_smfmac_f32_32x32x32_bf16 v[80:95], v[20:23], v[56:63], v5
  ds_read_b128 v[20:23], v4 offset:12480
  ds_read_b128 v[240:243], v3 offset:14560
  buffer_load_dwordx4 v[152:155], v1, s[52:55], s10 offen offset:2048 sc1
  v_exp_f32 v34, v34
  v_exp_f32 v35, v35
  v_exp_f32 v36, v36
  v_mfma_f32_32x32x16_bf16 v[48:63], v[12:15], v[8:11], v[64:79]
  ds_read_b128 v[12:15], v2 offset:16640
  v_exp_f32 v37, v37
  v_exp_f32 v38, v38
  v_exp_f32 v39, v39
  v_exp_f32 v40, v40
  v_exp_f32 v41, v41
  v_smfmac_f32_32x32x32_bf16 v[80:95], v[16:19], v[32:39], v5
  buffer_load_dwordx4 v[156:159], v1, s[52:55], s11 offen offset:2048 sc1
  buffer_load_dwordx4 v[160:163], v1, s[52:55], s12 offen offset:2048 sc1
  v_exp_f32 v42, v42
  v_exp_f32 v43, v43
  v_exp_f32 v44, v44
  v_exp_f32 v45, v45
  v_exp_f32 v46, v46
  v_exp_f32 v47, v47
  v_exp_f32 v48, v48
  v_exp_f32 v49, v49
  s_waitcnt lgkmcnt(0)
  v_smfmac_f32_32x32x32_bf16 v[80:95], v[20:23], v[40:47], v5
  ds_read_b128 v[20:23], v4 offset:14560
  ds_read_b128 v[16:19], v3 offset:16640
  buffer_load_dwordx4 v[164:167], v1, s[52:55], s10 offen offset:3072 sc1
  v_exp_f32 v50, v50
  v_exp_f32 v51, v51
  v_exp_f32 v52, v52
  v_mfma_f32_32x32x16_bf16 v[32:47], v[12:15], v[8:11], v[64:79]
  ds_read_b128 v[12:15], v2 offset:18720
  v_exp_f32 v53, v53
  v_exp_f32 v54, v54
  v_exp_f32 v55, v55
  v_exp_f32 v56, v56
  v_exp_f32 v57, v57
  v_smfmac_f32_32x32x32_bf16 v[80:95], v[240:243], v[48:55], v5
  buffer_load_dwordx4 v[168:171], v1, s[52:55], s11 offen offset:3072 sc1
  buffer_load_dwordx4 v[172:175], v1, s[52:55], s12 offen offset:3072 sc1
  v_exp_f32 v58, v58
  v_exp_f32 v59, v59
  v_exp_f32 v60, v60
  v_exp_f32 v61, v61
  v_exp_f32 v62, v62
  v_exp_f32 v63, v63
  v_add_u32 v2, 16640, v2
  v_add_u32 v3, 16640, v3
  v_add_u32 v4, 16640, v4
  s_mov_b32 s20, 0
  s_cmp_ge_u32 s56, 4
  s_cselect_b32 s21, 2, 7
L_attB:
  s_add_u32 s10, s10, 4096
  s_add_u32 s11, s11, 4096
  s_add_u32 s12, s12, 4096
  v_exp_f32 v32, v32
  v_exp_f32 v33, v33
  s_waitcnt lgkmcnt(0)
  v_smfmac_f32_32x32x32_bf16 v[80:95], v[20:23], v[56:63], v5
  ds_read_b128 v[20:23], v4 offset:0
  ds_read_b128 v[240:243], v3 offset:2080
  v_exp_f32 v34, v34
  v_exp_f32 v35, v35
  v_exp_f32 v36, v36
  v_mfma_f32_32x32x16_bf16 v[48:63], v[12:15], v[8:11], v[64:79]
  ds_read_b128 v[12:15], v2 offset:4160
  v_exp_f32 v37, v37
  v_exp_f32 v38, v38
  v_exp_f32 v39, v39
  v_exp_f32 v40, v40
  v_exp_f32 v41, v41
  v_smfmac_f32_32x32x32_bf16 v[80:95], v[16:19], v[32:39], v5
  v_exp_f32 v42, v42
  v_exp_f32 v43, v43
  v_exp_f32 v44, v44
  s_waitcnt vmcnt(9)
  v_mfma_f32_32x32x16_bf16 v[96:111], v[128:131], v[136:139], v[96:111]
  buffer_load_dwordx4 v[128:131], v1, s[52:55], s10 offen offset:0 sc1
  v_exp_f32 v45, v45
  v_exp_f32 v46, v46
  v_exp_f32 v47, v47
  v_exp_f32 v48, v48
  v_exp_f32 v49, v49
  s_waitcnt lgkmcnt(0)
  v_smfmac_f32_32x32x32_bf16 v[80:95], v[20:23], v[40:47], v5
  ds_read_b128 v[20:23], v4 offset:2080
  ds_read_b128 v[16:19], v3 offset:4160
  v_exp_f32 v50, v50
  v_exp_f32 v51, v51
  v_exp_f32 v52, v52
  v_mfma_f32_32x32x16_bf16 v[32:47], v[12:15], v[8:11], v[64:79]
  ds_read_b128 v[12:15], v2 offset:6240
  v_exp_f32 v53, v53
  v_exp_f32 v54, v54
  v_exp_f32 v55, v55
  v_exp_f32 v56, v56
  v_exp_f32 v57, v57
  v_smfmac_f32_32x32x32_bf16 v[80:95], v[240:243], v[48:55], v5
  v_exp_f32 v58, v58
  v_exp_f32 v59, v59
  v_exp_f32 v60, v60
  v_mfma_f32_32x32x16_bf16 v[112:127], v[132:135], v[136:139], v[112:127]
  buffer_load_dwordx4 v[132:135], v1, s[52:55], s11 offen offset:0 sc1
  buffer_load_dwordx4 v[136:139], v1, s[52:55], s12 offen offset:0 sc1
  v_exp_f32 v61, v61
  v_exp_f32 v62, v62
  v_exp_f32 v63, v63
  v_exp_f32 v32, v32
  v_exp_f32 v33, v33
  s_waitcnt lgkmcnt(0)
  v_smfmac_f32_32x32x32_bf16 v[80:95], v[20:23], v[56:63], v5
  ds_read_b128 v[20:23], v4 offset:4160
  ds_read_b128 v[240:243], v3 offset:6240
  v_exp_f32 v34, v34
  v_exp_f32 v35, v35
  v_exp_f32 v36, v36
  v_mfma_f32_32x32x16_bf16 v[48:63], v[12:15], v[8:11], v[64:79]
  ds_read_b128 v[12:15], v2 offset:8320
  v_exp_f32 v37, v37
  v_exp_f32 v38, v38
  v_exp_f32 v39, v39
  v_exp_f32 v40, v40
  v_exp_f32 v41, v41
  v_smfmac_f32_32x32x32_bf16 v[80:95], v[16:19], v[32:39], v5
  v_exp_f32 v42, v42
  v_exp_f32 v43, v43
  v_exp_f32 v44, v44
  s_waitcnt vmcnt(9)
  v_mfma_f32_32x32x16_bf16 v[96:111], v[140:143], v[148:151], v[96:111]
  buffer_load_dwordx4 v[140:143], v1, s[52:55], s10 offen offset:1024 sc1
  v_exp_f32 v45, v45
  v_exp_f32 v46, v46
  v_exp_f32 v47, v47
  v_exp_f32 v48, v48
  v_exp_f32 v49, v49
  s_waitcnt lgkmcnt(0)
  v_smfmac_f32_32x32x32_bf16 v[80:95], v[20:23], v[40:47], v5
  ds_read_b128 v[20:23], v4 offset:6240
  ds_read_b128 v[16:19], v3 offset:8320
  v_exp_f32 v50, v50
  v_exp_f32 v51, v51
  v_exp_f32 v52, v52
  v_mfma_f32_32x32x16_bf16 v[32:47], v[12:15], v[8:11], v[64:79]
  ds_read_b128 v[12:15], v2 offset:10400
  v_exp_f32 v53, v53
  v_exp_f32 v54, v54
  v_exp_f32 v55, v55
  v_exp_f32 v56, v56
  v_exp_f32 v57, v57
  v_smfmac_f32_32x32x32_bf16 v[80:95], v[240:243], v[48:55], v5
  v_exp_f32 v58, v58
  v_exp_f32 v59, v59
  v_exp_f32 v60, v60
  v_mfma_f32_32x32x16_bf16 v[112:127], v[144:147], v[148:151], v[112:127]
  buffer_load_dwordx4 v[144:147], v1, s[52:55], s11 offen offset:1024 sc1
  buffer_load_dwordx4 v[148:151], v1, s[52:55], s12 offen offset:1024 sc1
  v_exp_f32 v61, v61
  v_exp_f32 v62, v62
  v_exp_f32 v63, v63
  v_exp_f32 v32, v32
  v_exp_f32 v33, v33
  s_waitcnt lgkmcnt(0)
  v_smfmac_f32_32x32x32_bf16 v[80:95], v[20:23], v[56:63], v5
  ds_read_b128 v[20:23], v4 offset:8320
  ds_read_b128 v[240:243], v3 offset:10400
  v_exp_f32 v34, v34
  v_exp_f32 v35, v35
  v_exp_f32 v36, v36
  v_mfma_f32_32x32x16_bf16 v[48:63], v[12:15], v[8:11], v[64:79]
  ds_read_b128 v[12:15], v2 offset:12480
  v_exp_f32 v37, v37
  v_exp_f32 v38, v38
  v_exp_f32 v39, v39
  v_exp_f32 v40, v40
  v_exp_f32 v41, v41
  v_smfmac_f32_32x32x32_bf16 v[80:95], v[16:19], v[32:39], v5
  s_cmp_eq_u32 s20, 4
  s_cselect_b32 s10, 16777216, s10
  s_cselect_b32 s11, 16777216, s11
  s_cselect_b32 s12, 16777216, s12
  v_exp_f32 v42, v42
  v_exp_f32 v43, v43
  v_exp_f32 v44, v44
  s_waitcnt vmcnt(9)
  v_mfma_f32_32x32x16_bf16 v[96:111], v[152:155], v[160:163], v[96:111]
  buffer_load_dwordx4 v[152:155], v1, s[52:55], s10 offen offset:2048 sc1
  v_exp_f32 v45, v45
  v_exp_f32 v46, v46
  v_exp_f32 v47, v47
  v_exp_f32 v48, v48
  v_exp_f32 v49, v49
  s_waitcnt lgkmcnt(0)
  v_smfmac_f32_32x32x32_bf16 v[80:95], v[20:23], v[40:47], v5
  ds_read_b128 v[20:23], v4 offset:10400
  ds_read_b128 v[16:19], v3 offset:12480
  v_exp_f32 v50, v50
  v_exp_f32 v51, v51
  v_exp_f32 v52, v52
  v_mfma_f32_32x32x16_bf16 v[32:47], v[12:15], v[8:11], v[64:79]
  ds_read_b128 v[12:15], v2 offset:14560
  v_exp_f32 v53, v53
  v_exp_f32 v54, v54
  v_exp_f32 v55, v55
  v_exp_f32 v56, v56
  v_exp_f32 v57, v57
  v_smfmac_f32_32x32x32_bf16 v[80:95], v[240:243], v[48:55], v5
  v_exp_f32 v58, v58
  v_exp_f32 v59, v59
  v_exp_f32 v60, v60
  v_mfma_f32_32x32x16_bf16 v[112:127], v[156:159], v[160:163], v[112:127]
  buffer_load_dwordx4 v[156:159], v1, s[52:55], s11 offen offset:2048 sc1
  buffer_load_dwordx4 v[160:163], v1, s[52:55], s12 offen offset:2048 sc1
  v_exp_f32 v61, v61
  v_exp_f32 v62, v62
  v_exp_f32 v63, v63
  v_exp_f32 v32, v32
  v_exp_f32 v33, v33
  s_waitcnt lgkmcnt(0)
  v_smfmac_f32_32x32x32_bf16 v[80:95], v[20:23], v[56:63], v5
  ds_read_b128 v[20:23], v4 offset:12480
  ds_read_b128 v[240:243], v3 offset:14560
  v_exp_f32 v34, v34
  v_exp_f32 v35, v35
  v_exp_f32 v36, v36
  v_mfma_f32_32x32x16_bf16 v[48:63], v[12:15], v[8:11], v[64:79]
  ds_read_b128 v[12:15], v2 offset:16640
  v_exp_f32 v37, v37
  v_exp_f32 v38, v38
  v_exp_f32 v39, v39
  v_exp_f32 v40, v40
  v_exp_f32 v41, v41
  v_smfmac_f32_32x32x32_bf16 v[80:95], v[16:19], v[32:39], v5
  v_exp_f32 v42, v42
  v_exp_f32 v43, v43
  v_exp_f32 v44, v44
  s_waitcnt vmcnt(9)
  v_mfma_f32_32x32x16_bf16 v[96:111], v[164:167], v[172:175], v[96:111]
  buffer_load_dwordx4 v[164:167], v1, s[52:55], s10 offen offset:3072 sc1
  v_exp_f32 v45, v45
  v_exp_f32 v46, v46
  v_exp_f32 v47, v47
  v_exp_f32 v48, v48
  v_exp_f32 v49, v49
  s_waitcnt lgkmcnt(0)
  v_smfmac_f32_32x32x32_bf16 v[80:95], v[20:23], v[40:47], v5
  ds_read_b128 v[20:23], v4 offset:14560
  ds_read_b128 v[16:19], v3 offset:16640
  s_cmp_lg_u32 s20, s21
  s_cbranch_scc1 L_attB_np
  s_setprio 0
L_attB_np:
  v_exp_f32 v50, v50
  v_exp_f32 v51, v51
  v_exp_f32 v52, v52
  v_mfma_f32_32x32x16_bf16 v[32:47], v[12:15], v[8:11], v[64:79]
  ds_read_b128 v[12:15], v2 offset:18720
  v_exp_f32 v53, v53
  v_exp_f32 v54, v54
  v_exp_f32 v55, v55
  v_exp_f32 v56, v56
  v_exp_f32 v57, v57
  v_smfmac_f32_32x32x32_bf16 v[80:95], v[240:243], v[48:55], v5
  v_exp_f32 v58, v58
  v_exp_f32 v59, v59
  v_exp_f32 v60, v60
  v_mfma_f32_32x32x16_bf16 v[112:127], v[168:171], v[172:175], v[112:127]
  buffer_load_dwordx4 v[168:171], v1, s[52:55], s11 offen offset:3072 sc1
  buffer_load_dwordx4 v[172:175], v1, s[52:55], s12 offen offset:3072 sc1
  v_exp_f32 v61, v61
  v_exp_f32 v62, v62
  v_exp_f32 v63, v63
  v_add_u32 v2, 16640, v2
  v_add_u32 v3, 16640, v3
  v_add_u32 v4, 16640, v4
  s_add_u32 s20, s20, 1
  s_cmp_lt_u32 s20, 5
  s_cbranch_scc1 L_attB
  s_waitcnt lgkmcnt(0)
  v_smfmac_f32_32x32x32_bf16 v[80:95], v[20:23], v[56:63], v5
  s_waitcnt vmcnt(6)
  v_mfma_f32_32x32x16_bf16 v[96:111], v[128:131], v[136:139], v[96:111]
  v_mfma_f32_32x32x16_bf16 v[112:127], v[132:135], v[136:139], v[112:127]
  s_mov_b32 s21, 0xfffffffe
  s_mov_b32 s62, 0x5f800000
  s_nop 6
  v_fma_f32 v7, v80, 0, v88
  v_fma_f32 v7, v81, 0, v7
  v_fma_f32 v7, v82, 0, v7
  v_fma_f32 v7, v83, 0, v7
  v_fma_f32 v7, v84, 0, v7
  v_fma_f32 v7, v85, 0, v7
  v_fma_f32 v7, v86, 0, v7
  v_fma_f32 v7, v87, 0, v7
  v_cmp_ngt_f32 vcc, s62, v7
  s_cbranch_vccnz L_fallback
L_fb_done:
  v_rcp_f32 v6, v88
  s_nop 0
  v_mul_f32 v80, v80, v6
  v_mul_f32 v81, v81, v6
  v_mul_f32 v82, v82, v6
  v_mul_f32 v83, v83, v6
  v_mul_f32 v84, v84, v6
  v_mul_f32 v85, v85, v6
  v_mul_f32 v86, v86, v6
  v_mul_f32 v87, v87, v6
  v_cvt_pk_bf16_f32 v80, v80, v81
  v_cvt_pk_bf16_f32 v81, v82, v83
  v_cvt_pk_bf16_f32 v82, v84, v85
  v_cvt_pk_bf16_f32 v83, v86, v87
  v_min_u32 v80, s21, v80
  v_min_u32 v81, s21, v81
  v_min_u32 v82, s21, v82
  v_min_u32 v83, s21, v83
  buffer_store_dwordx4 v[80:83], v1, s[52:55], s14 offen sc1
  v_mov_b32 v10, 8204
  v_mov_b32 v11, 1
  s_mov_b64 exec, 1
  ds_add_u32 v10, v11
  s_mov_b64 exec, -1
  s_mov_b32 s20, 3
  s_mov_b32 s21, 0
  s_cmp_ge_u32 s56, 4
  s_cbranch_scc1 L_no21
  v_mfma_f32_32x32x16_bf16 v[96:111], v[140:143], v[148:151], v[96:111]
  v_mfma_f32_32x32x16_bf16 v[112:127], v[144:147], v[148:151], v[112:127]
L_no21:
  v_mov_b32 v6, 8204
  s_mov_b32 s62, 0
L_wD:
  ds_read_b32 v7, v6
  s_add_u32 s62, s62, 1
  s_cmp_ge_u32 s62, 4194304
  s_cbranch_scc1 L_wD_x
  s_waitcnt lgkmcnt(0)
  v_cmp_gt_u32 vcc, 8, v7
  s_cbranch_vccnz L_wD
L_wD_x:
  buffer_load_dwordx4 v[152:155], v1, s[52:55], s15 offen offset:0 sc1
  buffer_load_dwordx4 v[164:167], v1, s[52:55], s15 offen offset:1024 sc1
  buffer_load_dwordx4 v[156:159], v1, s[52:55], s15 offen offset:2048 sc1
  buffer_load_dwordx4 v[168:171], v1, s[52:55], s15 offen offset:3072 sc1
  buffer_load_dwordx4 v[160:163], v1, s[52:55], s66 offen offset:0 sc1
  buffer_load_dwordx4 v[172:175], v1, s[52:55], s66 offen offset:1024 sc1
  buffer_load_dwordx4 v[244:247], v1, s[52:55], s66 offen offset:2048 sc1
  buffer_load_dwordx4 v[248:251], v1, s[52:55], s66 offen offset:3072 sc1
  v_and_b32 v10, 31, v0
  v_lshrrev_b32 v11, 5, v0
  v_mul_u32_u24 v2, 528, v10
  v_lshl_add_u32 v2, v11, 8, v2
  s_and_b32 s62, s56, 1
  s_lshl_b32 s62, s62, 7
  s_lshr_b32 s63, s56, 1
  s_mul_i32 s63, s63, 16896
  s_add_u32 s62, s62, s63
  s_add_u32 s62, s62, 8448
  v_add_u32 v2, s62, v2
  v_lshrrev_b32 v6, 4, v0
  v_and_b32 v7, 15, v0
  v_mul_u32_u24 v3, 528, v6
  v_lshl_add_u32 v3, v7, 4, v3
  s_mul_i32 s62, s56, 2112
  s_add_u32 s62, s62, 8448
  v_add_u32 v3, s62, v3
  v_lshlrev_b32 v64, 16, v24
  v_and_b32 v65, 0xffff0000, v24
  v_lshlrev_b32 v66, 16, v25
  v_and_b32 v67, 0xffff0000, v25
  v_lshlrev_b32 v68, 16, v26
  v_and_b32 v69, 0xffff0000, v26
  v_lshlrev_b32 v70, 16, v27
  v_and_b32 v71, 0xffff0000, v27
  s_waitcnt vmcnt(4)
  v_max3_u32 v6, v152, v153, v154
  v_max3_u32 v7, v155, v164, v165
  v_max3_u32 v6, v6, v166, v167
  v_max3_u32 v7, v7, v156, v157
  v_max3_u32 v6, v6, v158, v159
  v_max3_u32 v7, v7, v168, v169
  v_max3_u32 v6, v6, v170, v171
  v_max_u32 v6, v6, v7
  v_cmp_eq_u32 vcc, -1, v6
  s_cbranch_vccnz L_og0
  v_mfma_f32_32x32x16_bf16 v[96:111], v[176:179], v[152:155], v[96:111]
  v_mfma_f32_32x32x16_bf16 v[112:127], v[208:211], v[152:155], v[112:127]
  v_mfma_f32_32x32x16_bf16 v[96:111], v[180:183], v[164:167], v[96:111]
  v_mfma_f32_32x32x16_bf16 v[112:127], v[212:215], v[164:167], v[112:127]
  v_mfma_f32_32x32x16_bf16 v[96:111], v[184:187], v[156:159], v[96:111]
  v_mfma_f32_32x32x16_bf16 v[112:127], v[216:219], v[156:159], v[112:127]
  v_mfma_f32_32x32x16_bf16 v[96:111], v[188:191], v[168:171], v[96:111]
  v_mfma_f32_32x32x16_bf16 v[112:127], v[220:223], v[168:171], v[112:127]
  s_bitset0_b32 s20, 0
L_og0:
  s_waitcnt vmcnt(0)
  v_max3_u32 v6, v160, v161, v162
  v_max3_u32 v7, v163, v172, v173
  v_max3_u32 v6, v6, v174, v175
  v_max3_u32 v7, v7, v244, v245
  v_max3_u32 v6, v6, v246, v247
  v_max3_u32 v7, v7, v248, v249
  v_max3_u32 v6, v6, v250, v251
  v_max_u32 v6, v6, v7
  v_cmp_eq_u32 vcc, -1, v6
  s_cbranch_vccnz L_og1
  v_mfma_f32_32x32x16_bf16 v[32:47], v[192:195], v[160:163], 0
  v_mfma_f32_32x32x16_bf16 v[48:63], v[224:227], v[160:163], 0
  v_mfma_f32_32x32x16_bf16 v[32:47], v[196:199], v[172:175], v[32:47]
  v_mfma_f32_32x32x16_bf16 v[48:63], v[228:231], v[172:175], v[48:63]
  v_mfma_f32_32x32x16_bf16 v[32:47], v[200:203], v[244:247], v[32:47]
  v_mfma_f32_32x32x16_bf16 v[48:63], v[232:235], v[244:247], v[48:63]
  v_mfma_f32_32x32x16_bf16 v[32:47], v[204:207], v[248:251], v[32:47]
  v_mfma_f32_32x32x16_bf16 v[48:63], v[236:239], v[248:251], v[48:63]
  s_bitset0_b32 s20, 1
L_og1:
  s_cmp_eq_u32 s20, 0
  s_cbranch_scc1 L_oready
L_opoll:
  s_bitcmp1_b32 s20, 0
  s_cbranch_scc0 L_op0
  buffer_load_dwordx4 v[152:155], v1, s[52:55], s15 offen offset:0 sc1
  buffer_load_dwordx4 v[164:167], v1, s[52:55], s15 offen offset:1024 sc1
  buffer_load_dwordx4 v[156:159], v1, s[52:55], s15 offen offset:2048 sc1
  buffer_load_dwordx4 v[168:171], v1, s[52:55], s15 offen offset:3072 sc1
L_op0:
  s_bitcmp1_b32 s20, 1
  s_cbranch_scc0 L_op1
  buffer_load_dwordx4 v[160:163], v1, s[52:55], s66 offen offset:0 sc1
  buffer_load_dwordx4 v[172:175], v1, s[52:55], s66 offen offset:1024 sc1
  buffer_load_dwordx4 v[244:247], v1, s[52:55], s66 offen offset:2048 sc1
  buffer_load_dwordx4 v[248:251], v1, s[52:55], s66 offen offset:3072 sc1
L_op1:
  s_add_u32 s21, s21, 1
  s_bitcmp1_b32 s20, 0
  s_waitcnt vmcnt(0)
  s_cbranch_scc0 L_og2
  v_max3_u32 v6, v152, v153, v154
  v_max3_u32 v7, v155, v164, v165
  v_max3_u32 v6, v6, v166, v167
  v_max3_u32 v7, v7, v156, v157
  v_max3_u32 v6, v6, v158, v159
  v_max3_u32 v7, v7, v168, v169
  v_max3_u32 v6, v6, v170, v171
  v_max_u32 v6, v6, v7
  v_cmp_eq_u32 vcc, -1, v6
  s_cbranch_vccnz L_og2
  v_mfma_f32_32x32x16_bf16 v[96:111], v[176:179], v[152:155], v[96:111]
  v_mfma_f32_32x32x16_bf16 v[112:127], v[208:211], v[152:155], v[112:127]
  v_mfma_f32_32x32x16_bf16 v[96:111], v[180:183], v[164:167], v[96:111]
  v_mfma_f32_32x32x16_bf16 v[112:127], v[212:215], v[164:167], v[112:127]
  v_mfma_f32_32x32x16_bf16 v[96:111], v[184:187], v[156:159], v[96:111]
  v_mfma_f32_32x32x16_bf16 v[112:127], v[216:219], v[156:159], v[112:127]
  v_mfma_f32_32x32x16_bf16 v[96:111], v[188:191], v[168:171], v[96:111]
  v_mfma_f32_32x32x16_bf16 v[112:127], v[220:223], v[168:171], v[112:127]
  s_bitset0_b32 s20, 0
L_og2:
  s_bitcmp1_b32 s20, 1
  s_cbranch_scc0 L_og3
  v_max3_u32 v6, v160, v161, v162
  v_max3_u32 v7, v163, v172, v173
  v_max3_u32 v6, v6, v174, v175
  v_max3_u32 v7, v7, v244, v245
  v_max3_u32 v6, v6, v246, v247
  v_max3_u32 v7, v7, v248, v249
  v_max3_u32 v6, v6, v250, v251
  v_max_u32 v6, v6, v7
  v_cmp_eq_u32 vcc, -1, v6
  s_cbranch_vccnz L_og3
  v_mfma_f32_32x32x16_bf16 v[32:47], v[192:195], v[160:163], 0
  v_mfma_f32_32x32x16_bf16 v[48:63], v[224:227], v[160:163], 0
  v_mfma_f32_32x32x16_bf16 v[32:47], v[196:199], v[172:175], v[32:47]
  v_mfma_f32_32x32x16_bf16 v[48:63], v[228:231], v[172:175], v[48:63]
  v_mfma_f32_32x32x16_bf16 v[32:47], v[200:203], v[244:247], v[32:47]
  v_mfma_f32_32x32x16_bf16 v[48:63], v[232:235], v[244:247], v[48:63]
  v_mfma_f32_32x32x16_bf16 v[32:47], v[204:207], v[248:251], v[32:47]
  v_mfma_f32_32x32x16_bf16 v[48:63], v[236:239], v[248:251], v[48:63]
  s_bitset0_b32 s20, 1
L_og3:
  s_cmp_eq_u32 s20, 0
  s_cbranch_scc1 L_oready
  s_cmp_lt_u32 s21, 262144
  s_cbranch_scc1 L_opoll
L_oready:
  s_nop 7
  s_nop 3
  v_pk_add_f32 v[96:97], v[96:97], v[32:33]
  v_pk_add_f32 v[98:99], v[98:99], v[34:35]
  ds_write_b128 v2, v[96:99] offset:0
  v_pk_add_f32 v[100:101], v[100:101], v[36:37]
  v_pk_add_f32 v[102:103], v[102:103], v[38:39]
  ds_write_b128 v2, v[100:103] offset:16
  v_pk_add_f32 v[104:105], v[104:105], v[40:41]
  v_pk_add_f32 v[106:107], v[106:107], v[42:43]
  ds_write_b128 v2, v[104:107] offset:32
  v_pk_add_f32 v[108:109], v[108:109], v[44:45]
  v_pk_add_f32 v[110:111], v[110:111], v[46:47]
  ds_write_b128 v2, v[108:111] offset:48
  v_pk_add_f32 v[112:113], v[112:113], v[48:49]
  v_pk_add_f32 v[114:115], v[114:115], v[50:51]
  ds_write_b128 v2, v[112:115] offset:64
  v_pk_add_f32 v[116:117], v[116:117], v[52:53]
  v_pk_add_f32 v[118:119], v[118:119], v[54:55]
  ds_write_b128 v2, v[116:119] offset:80
  v_pk_add_f32 v[120:121], v[120:121], v[56:57]
  v_pk_add_f32 v[122:123], v[122:123], v[58:59]
  ds_write_b128 v2, v[120:123] offset:96
  v_pk_add_f32 v[124:125], v[124:125], v[60:61]
  v_pk_add_f32 v[126:127], v[126:127], v[62:63]
  ds_write_b128 v2, v[124:127] offset:112
  s_waitcnt lgkmcnt(0)
  s_barrier
  ds_read_b128 v[32:35], v3 offset:0
  ds_read_b128 v[36:39], v3 offset:256
  ds_read_b128 v[40:43], v3 offset:16896
  ds_read_b128 v[44:47], v3 offset:17152
  ds_read_b128 v[48:51], v3 offset:33792
  ds_read_b128 v[52:55], v3 offset:34048
  ds_read_b128 v[56:59], v3 offset:50688
  ds_read_b128 v[60:63], v3 offset:50944
  s_waitcnt lgkmcnt(6)
  v_pk_add_f32 v[64:65], v[64:65], v[32:33]
  v_pk_add_f32 v[66:67], v[66:67], v[34:35]
  v_pk_add_f32 v[68:69], v[68:69], v[36:37]
  v_pk_add_f32 v[70:71], v[70:71], v[38:39]
  s_waitcnt lgkmcnt(4)
  v_pk_add_f32 v[64:65], v[64:65], v[40:41]
  v_pk_add_f32 v[66:67], v[66:67], v[42:43]
  v_pk_add_f32 v[68:69], v[68:69], v[44:45]
  v_pk_add_f32 v[70:71], v[70:71], v[46:47]
  s_waitcnt lgkmcnt(2)
  v_pk_add_f32 v[64:65], v[64:65], v[48:49]
  v_pk_add_f32 v[66:67], v[66:67], v[50:51]
  v_pk_add_f32 v[68:69], v[68:69], v[52:53]
  v_pk_add_f32 v[70:71], v[70:71], v[54:55]
  s_waitcnt lgkmcnt(0)
  v_pk_add_f32 v[64:65], v[64:65], v[56:57]
  v_pk_add_f32 v[66:67], v[66:67], v[58:59]
  v_pk_add_f32 v[68:69], v[68:69], v[60:61]
  v_pk_add_f32 v[70:71], v[70:71], v[62:63]
  v_cvt_pk_bf16_f32 v64, v64, v65
  v_cvt_pk_bf16_f32 v65, v66, v67
  v_cvt_pk_bf16_f32 v66, v68, v69
  v_cvt_pk_bf16_f32 v67, v70, v71
  buffer_store_dwordx4 v[64:67], v28, s[44:47], s16 offen
  s_waitcnt vmcnt(0)
L_end:
  s_endpgm
L_helper:
  s_sub_u32 s63, s56, 4
  s_mul_i32 s64, s63, 49152
  s_lshl_b32 s62, s60, 7
  s_add_u32 s62, s62, s64
  v_lshrrev_b32 v2, 3, v0
  v_mul_u32_u24 v3, 3072, v2
  v_and_b32 v4, 7, v0
  v_bfe_u32 v5, v0, 4, 1
  v_lshlrev_b32 v5, 2, v5
  v_xor_b32 v5, v5, v4
  v_lshl_add_u32 v3, v5, 4, v3
  v_add_u32 v32, s62, v3
  v_add_u32 v33, 23552, v32
  s_lshl_b32 s62, s60, 6
  s_add_u32 s62, s62, s64
  v_lshrrev_b32 v3, 2, v0
  v_mul_u32_u24 v3, 3072, v3
  v_and_b32 v5, 3, v0
  v_lshl_add_u32 v3, v5, 4, v3
  v_add_u32 v34, s62, v3
  s_mul_i32 s62, s60, 3
  s_min_u32 s62, s62, 40
  s_lshl_b32 s62, s62, 6
  s_mul_i32 s64, s63, 44032
  s_add_u32 s62, s62, s64
  v_add_u32 v3, 0, v0
  v_mul_u32_u24 v5, 171, v3
  v_lshrrev_b32 v5, 11, v5
  v_mul_u32_u24 v6, 12, v5
  v_sub_u32 v6, v3, v6
  v_mul_u32_u24 v5, 2752, v5
  v_add_u32 v5, s62, v5
  v_subrev_u32 v5, 0, v5
  v_lshl_add_u32 v36, v6, 4, v5
  v_xor_b32 v6, 2, v6
  v_lshl_add_u32 v40, v6, 4, v5
  v_add_u32 v3, 64, v0
  v_mul_u32_u24 v5, 171, v3
  v_lshrrev_b32 v5, 11, v5
  v_mul_u32_u24 v6, 12, v5
  v_sub_u32 v6, v3, v6
  v_mul_u32_u24 v5, 2752, v5
  v_add_u32 v5, s62, v5
  v_subrev_u32 v5, 1024, v5
  v_lshl_add_u32 v37, v6, 4, v5
  v_xor_b32 v6, 2, v6
  v_lshl_add_u32 v41, v6, 4, v5
  v_add_u32 v3, 128, v0
  v_mul_u32_u24 v5, 171, v3
  v_lshrrev_b32 v5, 11, v5
  v_mul_u32_u24 v6, 12, v5
  v_sub_u32 v6, v3, v6
  v_mul_u32_u24 v5, 2752, v5
  v_add_u32 v5, s62, v5
  v_subrev_u32 v5, 2048, v5
  v_lshl_add_u32 v38, v6, 4, v5
  v_xor_b32 v6, 2, v6
  v_lshl_add_u32 v42, v6, 4, v5
  v_lshlrev_b32 v44, 10, v2
  v_lshl_add_u32 v44, v4, 4, v44
  v_add_u32 v45, 7168, v44
  v_lshrrev_b32 v3, 5, v0
  v_bfe_u32 v5, v0, 2, 2
  v_lshl_add_u32 v3, v3, 2, v5
  v_lshlrev_b32 v3, 7, v3
  v_bfe_u32 v5, v0, 4, 1
  v_lshl_add_u32 v3, v5, 5, v3
  v_and_b32 v5, 3, v0
  v_lshl_add_u32 v3, v5, 3, v3
  s_lshl_b32 s70, s63, 11
  s_add_u32 s70, s70, 98304
  v_add_u32 v46, s70, v3
  v_mov_b32 v48, -1
  v_mov_b32 v49, -1
  v_mov_b32 v50, -1
  v_mov_b32 v51, -1
  s_mul_i32 s65, s63, 3072
  s_mul_i32 s66, s63, 6144
  s_waitcnt lgkmcnt(0)
  s_mov_b32 s3, 16252928
  s_load_dwordx2 s[100:101], s[52:53], s3
  s_barrier
  s_add_u32 s67, s61, 0
  s_and_b32 s67, s67, 7
  s_add_u32 m0, s65, 0
  s_mul_i32 s67, s67, 196608
  buffer_load_dwordx4 v32, s[28:31], s67 offen offset:0 lds
  buffer_load_dwordx4 v33, s[28:31], s67 offen offset:1024 lds
  buffer_load_dwordx4 v34, s[28:31], s67 offen offset:2048 lds
  s_add_u32 s67, s61, 1
  s_and_b32 s67, s67, 7
  s_add_u32 m0, s65, 12288
  s_mul_i32 s67, s67, 196608
  buffer_load_dwordx4 v32, s[28:31], s67 offen offset:0 lds
  buffer_load_dwordx4 v33, s[28:31], s67 offen offset:1024 lds
  buffer_load_dwordx4 v34, s[28:31], s67 offen offset:2048 lds
  s_add_u32 s67, s61, 2
  s_and_b32 s67, s67, 7
  s_add_u32 m0, s65, 24576
  s_mul_i32 s67, s67, 196608
  buffer_load_dwordx4 v32, s[28:31], s67 offen offset:0 lds
  buffer_load_dwordx4 v33, s[28:31], s67 offen offset:1024 lds
  buffer_load_dwordx4 v34, s[28:31], s67 offen offset:2048 lds
  s_add_u32 s67, s61, 3
  s_and_b32 s67, s67, 7
  s_add_u32 m0, s65, 36864
  s_mul_i32 s67, s67, 196608
  buffer_load_dwordx4 v32, s[28:31], s67 offen offset:0 lds
  buffer_load_dwordx4 v33, s[28:31], s67 offen offset:1024 lds
  buffer_load_dwordx4 v34, s[28:31], s67 offen offset:2048 lds
  s_waitcnt vmcnt(9) lgkmcnt(0)
  s_barrier
  s_add_u32 s67, s61, 4
  s_and_b32 s67, s67, 7
  s_add_u32 m0, s65, 49152
  s_mul_i32 s67, s67, 196608
  buffer_load_dwordx4 v32, s[28:31], s67 offen offset:0 lds
  buffer_load_dwordx4 v33, s[28:31], s67 offen offset:1024 lds
  buffer_load_dwordx4 v34, s[28:31], s67 offen offset:2048 lds
  s_add_u32 s67, s61, 5
  s_and_b32 s67, s67, 7
  s_add_u32 m0, s65, 61440
  s_mul_i32 s67, s67, 196608
  buffer_load_dwordx4 v32, s[28:31], s67 offen offset:0 lds
  buffer_load_dwordx4 v33, s[28:31], s67 offen offset:1024 lds
  buffer_load_dwordx4 v34, s[28:31], s67 offen offset:2048 lds
  s_waitcnt vmcnt(12) lgkmcnt(0)
  s_barrier
  s_add_u32 s67, s61, 6
  s_and_b32 s67, s67, 7
  s_add_u32 m0, s65, 73728
  s_mul_i32 s67, s67, 196608
  buffer_load_dwordx4 v32, s[28:31], s67 offen offset:0 lds
  buffer_load_dwordx4 v33, s[28:31], s67 offen offset:1024 lds
  buffer_load_dwordx4 v34, s[28:31], s67 offen offset:2048 lds
  s_add_u32 s67, s61, 7
  s_and_b32 s67, s67, 7
  s_add_u32 m0, s65, 86016
  s_mul_i32 s67, s67, 196608
  buffer_load_dwordx4 v32, s[28:31], s67 offen offset:0 lds
  buffer_load_dwordx4 v33, s[28:31], s67 offen offset:1024 lds
  buffer_load_dwordx4 v34, s[28:31], s67 offen offset:2048 lds
  s_waitcnt vmcnt(15) lgkmcnt(0)
  s_barrier
  s_add_u32 s67, s61, 0
  s_and_b32 s67, s67, 7
  s_add_u32 m0, s66, 114688
  s_mul_i32 s67, s67, 176128
  buffer_load_dwordx4 v36, s[32:35], s67 offen offset:0 lds
  buffer_load_dwordx4 v37, s[32:35], s67 offen offset:1024 lds
  buffer_load_dwordx4 v38, s[32:35], s67 offen offset:2048 lds
  s_add_u32 s67, s61, 0
  s_and_b32 s67, s67, 7
  s_add_u32 m0, s66, 117760
  s_mul_i32 s67, s67, 176128
  buffer_load_dwordx4 v40, s[36:39], s67 offen offset:0 lds
  buffer_load_dwordx4 v41, s[36:39], s67 offen offset:1024 lds
  buffer_load_dwordx4 v42, s[36:39], s67 offen offset:2048 lds
  s_waitcnt vmcnt(18) lgkmcnt(0)
  s_barrier
  s_add_u32 s67, s61, 1
  s_and_b32 s67, s67, 7
  s_add_u32 m0, s66, 139264
  s_mul_i32 s67, s67, 176128
  buffer_load_dwordx4 v36, s[32:35], s67 offen offset:0 lds
  buffer_load_dwordx4 v37, s[32:35], s67 offen offset:1024 lds
  buffer_load_dwordx4 v38, s[32:35], s67 offen offset:2048 lds
  s_lshr_b32 s62, s2, 1
  s_min_u32 s62, s62, 117
  s_and_b32 s64, s2, 1
  s_sub_u32 s67, s62, 86
  s_cmp_lt_u32 s62, 86
  s_cselect_b32 s40, s4, s40
  s_cselect_b32 s41, s5, s41
  s_cselect_b32 s42, 1409024, s42
  s_cselect_b32 s67, s62, s67
  s_lshl_b32 s67, s67, 14
  s_lshl2_add_u32 s64, s64, s63
  s_lshl_b32 s68, s64, 7
  s_add_u32 s67, s67, s68
  s_mov_b32 m0, s70
  s_mul_i32 s64, s64, 236
  buffer_load_dwordx4 v44, s[40:43], s67 offen lds
  buffer_load_dwordx4 v45, s[40:43], s67 offen offset:1024 lds
  s_add_u32 s64, s64, s62
  s_lshl_b32 s64, s64, 10
  s_add_u32 s71, s64, 11927552
  s_add_u32 s72, s71, 120832
  s_lshl3_add_u32 s62, s7, s63
  s_add_u32 s62, s62, s63
  s_lshl_b32 s62, s62, 5
  s_add_u32 s62, s62, s6
  s_lshl_b32 s62, s62, 10
  s_add_u32 s73, s62, 13893632
  s_add_u32 s74, s73, 32768
  s_waitcnt vmcnt(20) lgkmcnt(0)
  s_barrier
  s_add_u32 s67, s61, 1
  s_and_b32 s67, s67, 7
  s_add_u32 m0, s66, 142336
  s_mul_i32 s67, s67, 176128
  buffer_load_dwordx4 v40, s[36:39], s67 offen offset:0 lds
  buffer_load_dwordx4 v41, s[36:39], s67 offen offset:1024 lds
  buffer_load_dwordx4 v42, s[36:39], s67 offen offset:2048 lds
  s_waitcnt vmcnt(20) lgkmcnt(0)
  s_barrier
  s_add_u32 s67, s61, 2
  s_and_b32 s67, s67, 7
  s_add_u32 m0, s66, 0
  s_mul_i32 s67, s67, 176128
  buffer_load_dwordx4 v36, s[32:35], s67 offen offset:0 lds
  buffer_load_dwordx4 v37, s[32:35], s67 offen offset:1024 lds
  buffer_load_dwordx4 v38, s[32:35], s67 offen offset:2048 lds
  s_add_u32 s67, s61, 2
  s_and_b32 s67, s67, 7
  s_add_u32 m0, s66, 3072
  s_mul_i32 s67, s67, 176128
  buffer_load_dwordx4 v40, s[36:39], s67 offen offset:0 lds
  buffer_load_dwordx4 v41, s[36:39], s67 offen offset:1024 lds
  buffer_load_dwordx4 v42, s[36:39], s67 offen offset:2048 lds
  s_waitcnt vmcnt(23) lgkmcnt(0)
  s_barrier
  s_add_u32 s67, s61, 3
  s_and_b32 s67, s67, 7
  s_add_u32 m0, s66, 24576
  s_mul_i32 s67, s67, 176128
  buffer_load_dwordx4 v36, s[32:35], s67 offen offset:0 lds
  buffer_load_dwordx4 v37, s[32:35], s67 offen offset:1024 lds
  buffer_load_dwordx4 v38, s[32:35], s67 offen offset:2048 lds
  s_waitcnt vmcnt(23) lgkmcnt(0)
  s_barrier
  s_add_u32 s67, s61, 3
  s_and_b32 s67, s67, 7
  s_add_u32 m0, s66, 27648
  s_mul_i32 s67, s67, 176128
  buffer_load_dwordx4 v40, s[36:39], s67 offen offset:0 lds
  buffer_load_dwordx4 v41, s[36:39], s67 offen offset:1024 lds
  buffer_load_dwordx4 v42, s[36:39], s67 offen offset:2048 lds
  s_waitcnt vmcnt(20) lgkmcnt(0)
  s_barrier
  s_add_u32 s67, s61, 4
  s_and_b32 s67, s67, 7
  s_add_u32 m0, s66, 49152
  s_mul_i32 s67, s67, 176128
  buffer_load_dwordx4 v36, s[32:35], s67 offen offset:0 lds
  buffer_load_dwordx4 v37, s[32:35], s67 offen offset:1024 lds
  buffer_load_dwordx4 v38, s[32:35], s67 offen offset:2048 lds
  s_add_u32 s67, s61, 4
  s_and_b32 s67, s67, 7
  s_add_u32 m0, s66, 52224
  s_mul_i32 s67, s67, 176128
  buffer_load_dwordx4 v40, s[36:39], s67 offen offset:0 lds
  buffer_load_dwordx4 v41, s[36:39], s67 offen offset:1024 lds
  buffer_load_dwordx4 v42, s[36:39], s67 offen offset:2048 lds
  s_waitcnt vmcnt(21)
  ds_read_b64_tr_b16 v[52:53], v46
  ds_read_b64_tr_b16 v[54:55], v46 offset:1024
  ds_read_b64_tr_b16 v[56:57], v46 offset:64
  ds_read_b64_tr_b16 v[58:59], v46 offset:1088
  buffer_store_dwordx4 v[48:51], v1, s[52:55], s73 offen sc1
  buffer_store_dwordx4 v[48:51], v1, s[52:55], s74 offen sc1
  s_waitcnt lgkmcnt(0)
  buffer_store_dwordx4 v[52:55], v1, s[52:55], s71 offen sc1
  buffer_store_dwordx4 v[56:59], v1, s[52:55], s72 offen sc1
  s_waitcnt vmcnt(22) lgkmcnt(0)
  s_barrier
  s_add_u32 s67, s61, 5
  s_and_b32 s67, s67, 7
  s_add_u32 m0, s66, 73728
  s_mul_i32 s67, s67, 176128
  buffer_load_dwordx4 v36, s[32:35], s67 offen offset:0 lds
  buffer_load_dwordx4 v37, s[32:35], s67 offen offset:1024 lds
  buffer_load_dwordx4 v38, s[32:35], s67 offen offset:2048 lds
  s_add_u32 s67, s61, 5
  s_and_b32 s67, s67, 7
  s_add_u32 m0, s66, 76800
  s_mul_i32 s67, s67, 176128
  buffer_load_dwordx4 v40, s[36:39], s67 offen offset:0 lds
  buffer_load_dwordx4 v41, s[36:39], s67 offen offset:1024 lds
  buffer_load_dwordx4 v42, s[36:39], s67 offen offset:2048 lds
  s_waitcnt vmcnt(22) lgkmcnt(0)
  s_barrier
  s_add_u32 s67, s61, 6
  s_and_b32 s67, s67, 7
  s_add_u32 m0, s66, 114688
  s_mul_i32 s67, s67, 176128
  buffer_load_dwordx4 v36, s[32:35], s67 offen offset:0 lds
  buffer_load_dwordx4 v37, s[32:35], s67 offen offset:1024 lds
  buffer_load_dwordx4 v38, s[32:35], s67 offen offset:2048 lds
  s_add_u32 s67, s61, 6
  s_and_b32 s67, s67, 7
  s_add_u32 m0, s66, 117760
  s_mul_i32 s67, s67, 176128
  buffer_load_dwordx4 v40, s[36:39], s67 offen offset:0 lds
  buffer_load_dwordx4 v41, s[36:39], s67 offen offset:1024 lds
  buffer_load_dwordx4 v42, s[36:39], s67 offen offset:2048 lds
  s_waitcnt vmcnt(12) lgkmcnt(0)
  s_barrier
  s_add_u32 s67, s61, 7
  s_and_b32 s67, s67, 7
  s_add_u32 m0, s66, 139264
  s_mul_i32 s67, s67, 176128
  buffer_load_dwordx4 v36, s[32:35], s67 offen offset:0 lds
  buffer_load_dwordx4 v37, s[32:35], s67 offen offset:1024 lds
  buffer_load_dwordx4 v38, s[32:35], s67 offen offset:2048 lds
  s_add_u32 s67, s61, 7
  s_and_b32 s67, s67, 7
  s_add_u32 m0, s66, 142336
  s_mul_i32 s67, s67, 176128
  buffer_load_dwordx4 v40, s[36:39], s67 offen offset:0 lds
  buffer_load_dwordx4 v41, s[36:39], s67 offen offset:1024 lds
  buffer_load_dwordx4 v42, s[36:39], s67 offen offset:2048 lds
  s_waitcnt vmcnt(22) lgkmcnt(0)
  s_barrier
  v_lshlrev_b32 v2, 2, v0
  v_mov_b32 v3, 0
  ds_write_b32 v2, v3 offset:8192
  s_waitcnt vmcnt(0) lgkmcnt(0)
  s_barrier
  s_waitcnt lgkmcnt(0)
  s_add_u32 s100, s100, 2135587861
  s_addc_u32 s101, s101, 2654435769
  s_lshr_b32 s62, s2, 3
  s_add_u32 s62, s62, s2
  s_and_b32 s62, s62, 15
  s_lshl2_add_u32 s62, s62, s63
  s_lshl_b32 s62, s62, 9
  s_add_u32 s62, s62, 16269312
  v_lshlrev_b32 v6, 3, v0
  s_mov_b32 s20, 0
  s_mul_i32 s64, s6, 196608
  s_mul_i32 s65, s63, 12288
  s_add_u32 s17, s64, s65
  s_mul_i32 s18, s63, 8320
  s_add_u32 s18, s18, 8448
L_f1poll:
  buffer_load_dwordx2 v[8:9], v6, s[52:55], s62 offen sc1
  s_add_u32 s20, s20, 1
  s_waitcnt vmcnt(0)
  v_cmp_ne_u64 vcc, s[100:101], v[8:9]
  s_cbranch_vccz L_f1ok
  s_cmp_lt_u32 s20, 262144
  s_cbranch_scc1 L_f1poll
L_f1ok:
  s_lshr_b32 s62, s63, 1
  s_and_b32 s65, s7, 1
  s_cmp_lg_u32 s62, s65
  s_cbranch_scc1 L_noq
  s_and_b32 s62, s63, 1
  s_lshl_b32 m0, s62, 12
  s_lshl1_add_u32 s62, s7, s62
  s_mul_i32 s62, s62, 12288
  s_add_u32 s62, s62, s64
  s_add_u32 s62, s62, 2048
  buffer_load_dwordx4 v1, s[52:55], s62 offen offset:0 sc1 lds
  s_add_u32 s62, s62, 2048
  buffer_load_dwordx4 v1, s[52:55], s62 offen offset:1024 sc1 lds
  s_add_u32 s62, s62, 2048
  buffer_load_dwordx4 v1, s[52:55], s62 offen offset:2048 sc1 lds
  s_add_u32 s62, s62, 2048
  buffer_load_dwordx4 v1, s[52:55], s62 offen offset:3072 sc1 lds
L_noq:
  s_add_u32 m0, s18, 0
  s_add_u32 s62, s17, 0
  buffer_load_dwordx4 v1, s[52:55], s62 offen sc1 lds
  buffer_load_dwordx4 v1, s[52:55], s62 offen offset:1024 sc1 lds
  s_add_u32 m0, s18, 2080
  s_add_u32 s62, s17, 3072
  buffer_load_dwordx4 v1, s[52:55], s62 offen sc1 lds
  buffer_load_dwordx4 v1, s[52:55], s62 offen offset:1024 sc1 lds
  s_add_u32 m0, s18, 4160
  s_add_u32 s62, s17, 6144
  buffer_load_dwordx4 v1, s[52:55], s62 offen sc1 lds
  buffer_load_dwordx4 v1, s[52:55], s62 offen offset:1024 sc1 lds
  s_add_u32 m0, s18, 6240
  s_add_u32 s62, s17, 9216
  buffer_load_dwordx4 v1, s[52:55], s62 offen sc1 lds
  buffer_load_dwordx4 v1, s[52:55], s62 offen offset:1024 sc1 lds
  v_min_u32 v6, 18, v0
  v_mul_u32_u24 v6, 2080, v6
  v_mov_b32 v244, 0x3f803f80
  v_mov_b32 v245, 0x3f803f80
  v_mov_b32 v246, 0x3f803f80
  v_mov_b32 v247, 0x3f803f80
  v_mov_b32 v248, 0
  v_mov_b32 v249, 0
  v_mov_b32 v250, 0
  v_mov_b32 v251, 0
  ds_write_b128 v6, v[244:247] offset:10496
  ds_write_b128 v6, v[248:251] offset:10512
  v_and_b32 v29, 31, v0
  v_lshrrev_b32 v30, 5, v0
  v_and_b32 v2, 0x33, v0
  v_bfe_u32 v6, v0, 2, 1
  v_lshl_add_u32 v2, v6, 3, v2
  v_bfe_u32 v6, v0, 3, 1
  v_lshl_add_u32 v2, v6, 2, v2
  v_lshlrev_b32 v2, 4, v2
  v_add_u32 v2, 8448, v2
  v_lshl_add_u32 v6, v30, 4, v29
  v_lshlrev_b32 v6, 4, v6
  v_add_u32 v3, 9472, v6
  v_add_u32 v4, 9984, v6
  v_add_u32 v6, 4, v29
  v_and_b32 v6, 24, v6
  v_mov_b32 v7, 10512
  v_mov_b32 v5, 14672
  v_cmp_eq_u32 vcc, 24, v6
  s_nop 1
  v_cndmask_b32 v7, v7, v5, vcc
  v_and_b32 v6, 27, v29
  v_cmp_eq_u32 vcc, 16, v6
  v_subrev_u32 v5, 16, v7
  s_nop 0
  v_cndmask_b32 v7, v7, v5, vcc
  v_cmp_le_u32 vcc, 16, v29
  s_nop 1
  v_cndmask_b32 v3, v3, v7, vcc
  v_cndmask_b32 v4, v4, v7, vcc
  v_mov_b32 v5, 0xdddddddd
  v_mov_b32 v80, 0
  v_mov_b32 v81, 0
  v_mov_b32 v82, 0
  v_mov_b32 v83, 0
  v_mov_b32 v84, 0
  v_mov_b32 v85, 0
  v_mov_b32 v86, 0
  v_mov_b32 v87, 0
  v_mov_b32 v88, 0
  v_mov_b32 v89, 0
  v_mov_b32 v90, 0
  v_mov_b32 v91, 0
  v_mov_b32 v92, 0
  v_mov_b32 v93, 0
  v_mov_b32 v94, 0
  v_mov_b32 v95, 0
  v_mov_b32 v56, 0
  v_mov_b32 v57, 0
  v_mov_b32 v58, 0
  v_mov_b32 v59, 0
  v_mov_b32 v60, 0
  v_mov_b32 v61, 0
  v_mov_b32 v62, 0
  v_mov_b32 v63, 0
  v_mov_b32 v20, 0
  v_mov_b32 v21, 0
  v_mov_b32 v22, 0
  v_mov_b32 v23, 0
  s_and_b32 s62, s56, 1
  s_lshr_b32 s63, s56, 1
  s_mul_i32 s64, s63, 22
  s_add_u32 s65, s63, 1
  s_lshr_b32 s65, s65, 2
  s_sub_u32 s64, s64, s65
  s_lshl1_add_u32 s62, s9, s62
  s_mul_i32 s62, s62, 236
  s_add_u32 s62, s62, s64
  s_lshl_b32 s62, s62, 10
  s_add_u32 s10, s62, 11927552
  s_add_u32 s11, s10, 120832
  s_mul_i32 s62, s8, 86
  s_add_u32 s62, s62, s64
  s_lshl_b32 s62, s62, 10
  s_add_u32 s12, s62, 6291456
  s_and_b32 s62, s56, 3
  s_lshl2_add_u32 s62, s9, s62
  s_mul_i32 s62, s62, 118
  s_lshr_b32 s63, s56, 2
  s_lshl4_add_u32 s62, s63, s62
  s_add_u32 s62, s62, 86
  s_lshl_b32 s62, s62, 10
  s_add_u32 s13, s62, 11927552
  s_lshl3_add_u32 s62, s7, s56
  s_lshl_b32 s62, s62, 5
  s_add_u32 s62, s62, s6
  s_lshl_b32 s62, s62, 10
  s_add_u32 s14, s62, 13893632
  s_lshl3_add_u32 s62, s8, s56
  s_lshl_b32 s62, s62, 12
  s_add_u32 s15, s62, 13893632
  s_lshl3_add_u32 s62, s8, s56
  s_lshl_b32 s62, s62, 12
  s_lshl_b32 s63, s9, 8
  s_add_u32 s16, s62, s63
  v_lshrrev_b32 v6, 4, v0
  v_and_b32 v7, 15, v0
  v_lshlrev_b32 v28, 10, v6
  v_lshl_add_u32 v28, v7, 4, v28
  s_and_b32 s62, s56, 1
  s_lshl1_add_u32 s62, s9, s62
  s_mul_i32 s62, s62, 236
  s_lshr_b32 s63, s56, 1
  s_lshl3_add_u32 s62, s63, s62
  s_add_u32 s62, s62, 86
  s_lshl_b32 s62, s62, 10
  s_add_u32 s13, s62, 11927552
  s_lshl2_add_u32 s62, s8, s63
  s_lshl_b32 s62, s62, 13
  s_add_u32 s15, s62, 13893632
  s_add_u32 s66, s15, 4096
  v_lshlrev_b32 v31, 3, v7
  s_lshl_b32 s62, s8, 7
  s_add_u32 s3, s62, 16257024
  s_lshl2_add_u32 s62, s59, s56
  s_lshl4_add_u32 s62, s62, s60
  s_lshl3_add_u32 s19, s62, 16257024
  s_cmp_lt_u32 s56, 4
  s_cselect_b32 s21, 7, 0
  s_cselect_b32 s22, 0, 7
  s_cselect_b32 s23, 7, 1
  v_mov_b32 v96, 0
  v_mov_b32 v97, 0
  v_mov_b32 v98, 0
  v_mov_b32 v99, 0
  v_mov_b32 v100, 0
  v_mov_b32 v101, 0
  v_mov_b32 v102, 0
  v_mov_b32 v103, 0
  v_mov_b32 v104, 0
  v_mov_b32 v105, 0
  v_mov_b32 v106, 0
  v_mov_b32 v107, 0
  v_mov_b32 v108, 0
  v_mov_b32 v109, 0
  v_mov_b32 v110, 0
  v_mov_b32 v111, 0
  v_mov_b32 v112, 0
  v_mov_b32 v113, 0
  v_mov_b32 v114, 0
  v_mov_b32 v115, 0
  v_mov_b32 v116, 0
  v_mov_b32 v117, 0
  v_mov_b32 v118, 0
  v_mov_b32 v119, 0
  v_mov_b32 v120, 0
  v_mov_b32 v121, 0
  v_mov_b32 v122, 0
  v_mov_b32 v123, 0
  v_mov_b32 v124, 0
  v_mov_b32 v125, 0
  v_mov_b32 v126, 0
  v_mov_b32 v127, 0
  s_waitcnt vmcnt(0) lgkmcnt(0)
  v_mov_b32 v6, 8192
  v_mov_b32 v7, 1
  s_mov_b64 exec, 1
  ds_add_u32 v6, v7
  s_mov_b64 exec, -1
  s_setprio 2
  s_branch L_att
L_fallback:
  v_subrev_u32 v2, 133120, v2
  v_subrev_u32 v3, 133120, v3
  v_subrev_u32 v4, 133120, v4
  v_mov_b32 v6, 0xff800000
  v_mov_b32 v7, v2
  s_mov_b32 s20, 0
L_fbA:
  ds_read_b128 v[12:15], v7
  v_add_u32 v7, 2080, v7
  s_waitcnt lgkmcnt(0)
  v_mfma_f32_32x32x16_bf16 v[32:47], v[12:15], v[8:11], 0
  s_nop 11
  v_max3_f32 v6, v6, v32, v33
  v_max3_f32 v6, v6, v34, v35
  v_max3_f32 v6, v6, v36, v37
  v_max3_f32 v6, v6, v38, v39
  v_max3_f32 v6, v6, v40, v41
  v_max3_f32 v6, v6, v42, v43
  v_max3_f32 v6, v6, v44, v45
  v_max3_f32 v6, v6, v46, v47
  s_add_u32 s20, s20, 1
  s_cmp_lt_u32 s20, 64
  s_cbranch_scc1 L_fbA
  v_mov_b32 v7, v6
  s_nop 1
  v_permlane32_swap_b32 v6, v7
  v_max_f32 v6, v6, v7
  v_sub_f32 v64, 0, v6
  v_sub_f32 v65, 0, v6
  v_sub_f32 v66, 0, v6
  v_sub_f32 v67, 0, v6
  v_sub_f32 v68, 0, v6
  v_sub_f32 v69, 0, v6
  v_sub_f32 v70, 0, v6
  v_sub_f32 v71, 0, v6
  v_sub_f32 v72, 0, v6
  v_sub_f32 v73, 0, v6
  v_sub_f32 v74, 0, v6
  v_sub_f32 v75, 0, v6
  v_sub_f32 v76, 0, v6
  v_sub_f32 v77, 0, v6
  v_sub_f32 v78, 0, v6
  v_sub_f32 v79, 0, v6
  v_mov_b32 v80, 0
  v_mov_b32 v81, 0
  v_mov_b32 v82, 0
  v_mov_b32 v83, 0
  v_mov_b32 v84, 0
  v_mov_b32 v85, 0
  v_mov_b32 v86, 0
  v_mov_b32 v87, 0
  v_mov_b32 v88, 0
  v_mov_b32 v89, 0
  v_mov_b32 v90, 0
  v_mov_b32 v91, 0
  v_mov_b32 v92, 0
  v_mov_b32 v93, 0
  v_mov_b32 v94, 0
  v_mov_b32 v95, 0
  s_mov_b32 s20, 0
L_fbB:
  ds_read_b128 v[12:15], v2
  ds_read_b128 v[16:19], v3
  ds_read_b128 v[20:23], v4
  v_add_u32 v2, 2080, v2
  v_add_u32 v3, 2080, v3
  v_add_u32 v4, 2080, v4
  s_waitcnt lgkmcnt(0)
  v_mfma_f32_32x32x16_bf16 v[32:47], v[12:15], v[8:11], v[64:79]
  s_nop 11
  v_exp_f32 v32, v32
  v_exp_f32 v33, v33
  v_exp_f32 v34, v34
  v_exp_f32 v35, v35
  v_exp_f32 v36, v36
  v_exp_f32 v37, v37
  v_exp_f32 v38, v38
  v_exp_f32 v39, v39
  v_exp_f32 v40, v40
  v_exp_f32 v41, v41
  v_exp_f32 v42, v42
  v_exp_f32 v43, v43
  v_exp_f32 v44, v44
  v_exp_f32 v45, v45
  v_exp_f32 v46, v46
  v_exp_f32 v47, v47
  s_nop 1
  v_smfmac_f32_32x32x32_bf16 v[80:95], v[16:19], v[32:39], v5
  v_smfmac_f32_32x32x32_bf16 v[80:95], v[20:23], v[40:47], v5
  s_add_u32 s20, s20, 1
  s_cmp_lt_u32 s20, 64
  s_cbranch_scc1 L_fbB
  s_nop 11
  s_branch L_fb_done
L_f2slow:
  s_mov_b32 s20, 0
L_f2poll:
  buffer_load_dwordx2 v[6:7], v31, s[52:55], s3 offen sc1
  s_add_u32 s20, s20, 1
  s_waitcnt vmcnt(0)
  v_cmp_ne_u64 vcc, s[100:101], v[6:7]
  s_cbranch_vccz L_f2ok
  s_cmp_lt_u32 s20, 262144
  s_cbranch_scc1 L_f2poll
  s_branch L_f2ok
L_codeend:
.section .rodata,"a"
.p2align 6
.amdhsa_kernel parallel_sum__softmax_full_mha__glu_gated_reglu__prompt_kernel
  .amdhsa_next_free_vgpr 256
  .amdhsa_next_free_sgpr 102
  .amdhsa_accum_offset 256
  .amdhsa_group_segment_fixed_size 0
  .amdhsa_kernarg_size 80
  .amdhsa_user_sgpr_count 2
  .amdhsa_user_sgpr_kernarg_segment_ptr 1
  .amdhsa_system_sgpr_workgroup_id_x 1
  .amdhsa_float_denorm_mode_32 3
.end_amdhsa_kernel
```
